```python
import torch

def _softmax(x, axis=-1):
    return torch.softmax(x, dim=axis)
def _gelu(x):
    return torch.nn.functional.gelu(x, approximate="tanh")
def _silu(x):
    return torch.nn.functional.silu(x)
def _sigmoid(x):
    return torch.sigmoid(x)
def _layernorm(x, axis=-1, eps=1e-5):
    m = x.mean(dim=axis, keepdim=True)
    v = x.var(dim=axis, keepdim=True, unbiased=False)
    return (x - m) / torch.sqrt(v + eps)
def _scatter_add(tgt, idx, src, axis=0):
    return tgt.clone().index_add_(axis, idx, src)
def _segment_sum(src, seg, n):
    out = torch.zeros((n,) + src.shape[1:], dtype=src.dtype)
    return out.index_add_(0, seg, src)
def _pad(x, pw):
    flat = tuple(v for pair in reversed(pw) for v in pair)
    return torch.nn.functional.pad(x, flat)

kernel_name = 'standalone__batchnorm__sampling'

def setup_inputs():

    _w = (lambda a: (lambda t: t.to(torch.bfloat16) if t.is_floating_point() else t)(torch.as_tensor(a)))
    B, S, C = 1024, 8, 640
    K = 3
    return {
        "x": _w((lambda *s: torch.randn(*s, dtype=torch.bfloat16) * 0.05)(B, S, C)),
        "w": _w((lambda *s: torch.randn(*s, dtype=torch.bfloat16) * 0.05)(K, C, C) * (1.0 / (K * C) ** 0.5)),
        "mean": _w((lambda *s: torch.randn(*s, dtype=torch.bfloat16) * 0.05)(C) * 0.1),
        "var": _w(torch.abs((lambda *s: torch.randn(*s, dtype=torch.bfloat16) * 0.05)(C)) + 0.5),
        "g": _w((lambda *s: torch.randn(*s, dtype=torch.bfloat16) * 0.05)(C) + 1.0),
        "b": _w((lambda *s: torch.randn(*s, dtype=torch.bfloat16) * 0.05)(C) * 0.1),
    }

def reference(x, w, mean, var, g, b):
    K = 3
    P = K // 2
    S = x.shape[1]
    xp = _pad(x, ((0, 0), (P, P), (0, 0)))
    y = sum(torch.einsum('bsc,cd->bsd', xp[:, k:k + S, :], w[k]) for k in range(K))
    inv_std = 1.0 / torch.sqrt(var + 1e-5)
    y = (y - mean) * (g * inv_std) + b
    return _silu(y)
```

```asm
; @launch grid=(256,1,1) block=(512,1,1) lds=163840
.amdgcn_target "amdgcn-amd-amdhsa--gfx950"
.text
.globl standalone__batchnorm__sampling_kernel
.p2align 8
.type standalone__batchnorm__sampling_kernel,@function
standalone__batchnorm__sampling_kernel:
  s_load_dwordx16 s[4:19], s[0:1], 0
  s_cmp_ge_u32 s2, 256
  s_cbranch_scc1 L_exit
  v_lshrrev_b32 v1, 6, v0
  v_and_b32 v0, 63, v0
  s_and_b32 s20, s2, 7
  v_readfirstlane_b32 s23, v1
  s_lshr_b32 s25, s2, 3
  s_lshr_b32 s22, s25, 3
  s_and_b32 s21, s25, 7
  s_lshl_b32 s20, s20, 2
  s_add_u32 s20, s20, s22
  s_mul_i32 s26, s20, 327680
  s_mul_i32 s27, s21, 160
  s_cmp_ge_u32 s23, 4
  s_cbranch_scc1 L_cons_sel
L_producer:
  v_lshrrev_b32 v2, 3, v0
  v_lshrrev_b32 v3, 4, v0
  s_and_b32 s29, s23, 1
  s_lshl_b32 s29, s29, 2
  v_add_u32 v3, s29, v3
  v_and_b32 v4, 7, v0
  v_xor_b32 v4, v4, v3
  v_mul_u32_u24 v2, 10240, v2
  v_lshl_add_u32 v10, v4, 4, v2
  s_mul_i32 s46, s23, 81920
  s_add_u32 s46, s46, s26
  s_lshl_b32 s41, s23, 10
  s_mov_b32 s51, 98304
  s_mov_b32 s34, 10485760
  s_mov_b32 s35, 0x20000
  s_mov_b32 s38, 2457600
  s_waitcnt lgkmcnt(0)
  s_mov_b32 s32, s4
  s_and_b32 s33, s5, 0xffff
  s_mov_b32 s36, s6
  s_and_b32 s37, s7, 0xffff
  s_mov_b32 m0, s41
  s_addk_i32 s41, 16384
  buffer_load_dwordx4 v10, s[32:35], s46 offen  lds
  s_addk_i32 m0, 0x1000
  s_addk_i32 s46, 1280
  buffer_load_dwordx4 v10, s[32:35], s46 offen  lds
  s_addk_i32 m0, 0x1000
  s_addk_i32 s46, 1280
  buffer_load_dwordx4 v10, s[32:35], s46 offen  lds
  s_addk_i32 m0, 0x1000
  s_addk_i32 s46, 1280
  buffer_load_dwordx4 v10, s[32:35], s46 offen  lds
  s_addk_i32 s46, 1280
  s_and_b32 s29, s23, 1
  s_and_b32 s28, s23, 2
  s_cmp_eq_u32 s28, 0
  s_cbranch_scc0 L_touch_w
  s_lshl_b32 s30, s29, 4
  v_add_u32 v3, s30, v0
  v_mul_u32_u24 v3, 10240, v3
  s_mul_i32 s30, s21, 1280
  v_add_u32 v3, s30, v3
  v_cmp_gt_u32 vcc, 16, v0
  s_mov_b32 s53, s26
  s_movk_i32 s55, 128
  s_mov_b32 s58, s34
  s_waitcnt lgkmcnt(0)
  s_mov_b32 s56, s4
  s_and_b32 s57, s5, 0xffff
  s_branch L_touch_j
L_touch_w:
  v_mul_u32_u24 v3, 6554, v0
  v_lshrrev_b32 v3, 16, v3
  v_mul_u32_u24 v4, 10, v3
  v_sub_u32 v4, v0, v4
  s_lshl_b32 s30, s2, 3
  s_lshl_b32 s31, s29, 2
  s_add_u32 s30, s30, s31
  v_add_u32 v3, s30, v3
  v_mul_u32_u24 v3, 1280, v3
  v_lshl_add_u32 v3, v4, 7, v3
  v_cmp_gt_u32 vcc, 40, v0
  s_mov_b32 s53, 0x0
  s_mov_b32 s55, 0x4000000
  s_mov_b32 s58, s38
  s_waitcnt lgkmcnt(0)
  s_mov_b32 s56, s6
  s_and_b32 s57, s7, 0xffff
L_touch_j:
  s_mov_b32 s59, s35
  v_mov_b32 v4, 0x40000000
  v_cndmask_b32 v20, v4, v3, vcc
  buffer_load_dword v21, v20, s[56:59], s53 offen
  s_mov_b32 m0, s41
  s_addk_i32 s41, 16384
  buffer_load_dwordx4 v10, s[32:35], s46 offen  lds
  s_addk_i32 m0, 0x1000
  s_addk_i32 s46, 1280
  buffer_load_dwordx4 v10, s[32:35], s46 offen  lds
  s_addk_i32 m0, 0x1000
  s_addk_i32 s46, 1280
  buffer_load_dwordx4 v10, s[32:35], s46 offen  lds
  s_addk_i32 m0, 0x1000
  s_addk_i32 s46, 1280
  buffer_load_dwordx4 v10, s[32:35], s46 offen  lds
  s_addk_i32 s46, -8832
  s_sub_u32 s44, s41, s51
  s_cselect_b32 s41, s41, s44
  v_lshl_add_u32 v7, s23, 6, v0
  v_mul_u32_u24 v3, 6554, v7
  v_lshrrev_b32 v3, 16, v3
  v_mul_u32_u24 v4, 10, v3
  v_sub_u32 v4, v7, v4
  v_bfe_u32 v5, v3, 2, 2
  v_lshlrev_b32 v5, 3, v5
  v_bfe_u32 v6, v3, 4, 1
  v_lshl_add_u32 v5, v6, 2, v5
  v_and_b32 v6, 3, v3
  v_add_u32 v5, v5, v6
  v_mul_u32_u24 v5, 1280, v5
  v_lshl_add_u32 v5, v4, 4, v5
  v_lshrrev_b32 v6, 5, v3
  v_mul_u32_u24 v6, 819200, v6
  v_add_u32 v11, v5, v6
  v_add_u32 v7, 0x100, v7
  v_mul_u32_u24 v3, 6554, v7
  v_lshrrev_b32 v3, 16, v3
  v_mul_u32_u24 v4, 10, v3
  v_sub_u32 v4, v7, v4
  v_bfe_u32 v5, v3, 2, 2
  v_lshlrev_b32 v5, 3, v5
  v_bfe_u32 v6, v3, 4, 1
  v_lshl_add_u32 v5, v6, 2, v5
  v_and_b32 v6, 3, v3
  v_add_u32 v5, v5, v6
  v_mul_u32_u24 v5, 1280, v5
  v_lshl_add_u32 v5, v4, 4, v5
  v_lshrrev_b32 v6, 5, v3
  v_mul_u32_u24 v6, 819200, v6
  v_add_u32 v12, v5, v6
  v_add_u32 v7, 0x100, v7
  v_mul_u32_u24 v3, 6554, v7
  v_lshrrev_b32 v3, 16, v3
  v_mul_u32_u24 v4, 10, v3
  v_sub_u32 v4, v7, v4
  v_bfe_u32 v5, v3, 2, 2
  v_lshlrev_b32 v5, 3, v5
  v_bfe_u32 v6, v3, 4, 1
  v_lshl_add_u32 v5, v6, 2, v5
  v_and_b32 v6, 3, v3
  v_add_u32 v5, v5, v6
  v_mul_u32_u24 v5, 1280, v5
  v_lshl_add_u32 v5, v4, 4, v5
  v_lshrrev_b32 v6, 5, v3
  v_mul_u32_u24 v6, 819200, v6
  v_add_u32 v13, v5, v6
  v_add_u32 v7, 0x100, v7
  v_mul_u32_u24 v3, 6554, v7
  v_lshrrev_b32 v3, 16, v3
  v_mul_u32_u24 v4, 10, v3
  v_sub_u32 v4, v7, v4
  v_bfe_u32 v5, v3, 2, 2
  v_lshlrev_b32 v5, 3, v5
  v_bfe_u32 v6, v3, 4, 1
  v_lshl_add_u32 v5, v6, 2, v5
  v_and_b32 v6, 3, v3
  v_add_u32 v5, v5, v6
  v_mul_u32_u24 v5, 1280, v5
  v_lshl_add_u32 v5, v4, 4, v5
  v_lshrrev_b32 v6, 5, v3
  v_mul_u32_u24 v6, 819200, v6
  v_add_u32 v14, v5, v6
  s_lshl_b32 s42, s23, 10
  s_add_u32 s42, s42, 98304
  s_mov_b32 s47, s27
  s_mov_b32 s43, 0
  s_movk_i32 s48, 0x4000
  s_mov_b32 s49, 40960
  s_mov_b32 s50, 0xffff
  s_mov_b32 s39, s35
  s_add_u32 m0, s42, s43
  s_add_u32 s43, s43, s48
  buffer_load_dwordx4 v11, s[36:39], s47 offen  lds
  s_addk_i32 m0, 0x1000
  s_and_b32 s43, s43, s50
  buffer_load_dwordx4 v12, s[36:39], s47 offen  lds
  s_addk_i32 m0, 0x1000
  s_nop 0
  buffer_load_dwordx4 v13, s[36:39], s47 offen  lds
  s_addk_i32 m0, 0x1000
  s_nop 0
  buffer_load_dwordx4 v14, s[36:39], s47 offen  lds
  s_add_u32 s47, s47, s49
  s_add_u32 s53, s53, s55
  buffer_load_dword v21, v20, s[56:59], s53 offen
  s_add_u32 s53, s53, s55
  buffer_load_dword v21, v20, s[56:59], s53 offen
  s_add_u32 m0, s42, s43
  s_add_u32 s43, s43, s48
  buffer_load_dwordx4 v11, s[36:39], s47 offen  lds
  s_addk_i32 m0, 0x1000
  s_and_b32 s43, s43, s50
  buffer_load_dwordx4 v12, s[36:39], s47 offen  lds
  s_addk_i32 m0, 0x1000
  s_nop 0
  buffer_load_dwordx4 v13, s[36:39], s47 offen  lds
  s_addk_i32 m0, 0x1000
  s_nop 0
  buffer_load_dwordx4 v14, s[36:39], s47 offen  lds
  s_add_u32 s47, s47, s49
  s_mov_b32 s72, s16
  s_and_b32 s73, s17, 0xffff
  s_mov_b32 s74, s34
  s_mov_b32 s75, s35
  s_add_u32 s76, s26, s27
  s_add_u32 s77, s76, 5120
  s_mul_i32 s78, s23, 1408
  s_mul_i32 s79, s23, 81920
  v_add_u32 v3, 0, v0
  v_mul_u32_u24 v4, 6554, v3
  v_lshrrev_b32 v4, 16, v4
  v_mul_u32_u24 v5, 10, v4
  v_sub_u32 v5, v3, v5
  v_mul_u32_u24 v6, 176, v4
  v_lshl_add_u32 v6, v5, 4, v6
  v_add_u32 v22, s78, v6
  v_mul_u32_u24 v6, 10240, v4
  v_lshl_add_u32 v6, v5, 4, v6
  v_add_u32 v26, s79, v6
  v_add_u32 v3, 64, v0
  v_min_u32 v3, 79, v3
  v_mul_u32_u24 v4, 6554, v3
  v_lshrrev_b32 v4, 16, v4
  v_mul_u32_u24 v5, 10, v4
  v_sub_u32 v5, v3, v5
  v_mul_u32_u24 v6, 176, v4
  v_lshl_add_u32 v6, v5, 4, v6
  v_add_u32 v23, s78, v6
  v_mul_u32_u24 v6, 10240, v4
  v_lshl_add_u32 v6, v5, 4, v6
  v_add_u32 v27, s79, v6
  v_cmp_gt_u32 vcc, 16, v0
  v_mov_b32 v7, 0x40000000
  s_nop 0
  v_cndmask_b32 v27, v7, v27, vcc
  s_waitcnt vmcnt(6)
  s_barrier
  s_mov_b32 m0, s41
  s_addk_i32 s41, 16384
  buffer_load_dwordx4 v10, s[32:35], s46 offen  lds
  s_addk_i32 m0, 0x1000
  s_addk_i32 s46, 1280
  buffer_load_dwordx4 v10, s[32:35], s46 offen  lds
  s_addk_i32 m0, 0x1000
  s_addk_i32 s46, 1280
  buffer_load_dwordx4 v10, s[32:35], s46 offen  lds
  s_addk_i32 m0, 0x1000
  s_addk_i32 s46, 1280
  buffer_load_dwordx4 v10, s[32:35], s46 offen  lds
  s_addk_i32 s46, 1280
  s_mov_b32 m0, s41
  s_addk_i32 s41, 16384
  buffer_load_dwordx4 v10, s[32:35], s46 offen  lds
  s_addk_i32 m0, 0x1000
  s_addk_i32 s46, 1280
  buffer_load_dwordx4 v10, s[32:35], s46 offen  lds
  s_addk_i32 m0, 0x1000
  s_addk_i32 s46, 1280
  buffer_load_dwordx4 v10, s[32:35], s46 offen  lds
  s_addk_i32 m0, 0x1000
  s_addk_i32 s46, 1280
  buffer_load_dwordx4 v10, s[32:35], s46 offen  lds
  s_addk_i32 s46, -8832
  s_sub_u32 s44, s41, s51
  s_cselect_b32 s41, s41, s44
  s_add_u32 m0, s42, s43
  s_add_u32 s43, s43, s48
  buffer_load_dwordx4 v11, s[36:39], s47 offen  lds
  s_addk_i32 m0, 0x1000
  s_and_b32 s43, s43, s50
  buffer_load_dwordx4 v12, s[36:39], s47 offen  lds
  s_addk_i32 m0, 0x1000
  s_nop 0
  buffer_load_dwordx4 v13, s[36:39], s47 offen  lds
  s_addk_i32 m0, 0x1000
  s_nop 0
  buffer_load_dwordx4 v14, s[36:39], s47 offen  lds
  s_add_u32 s47, s47, s49
  s_add_u32 s53, s53, s55
  buffer_load_dword v21, v20, s[56:59], s53 offen
  s_waitcnt vmcnt(13)
  s_barrier
  s_add_u32 m0, s42, s43
  s_add_u32 s43, s43, s48
  buffer_load_dwordx4 v11, s[36:39], s47 offen  lds
  s_addk_i32 m0, 0x1000
  s_and_b32 s43, s43, s50
  buffer_load_dwordx4 v12, s[36:39], s47 offen  lds
  s_addk_i32 m0, 0x1000
  s_nop 0
  buffer_load_dwordx4 v13, s[36:39], s47 offen  lds
  s_addk_i32 m0, 0x1000
  s_nop 0
  buffer_load_dwordx4 v14, s[36:39], s47 offen  lds
  s_add_u32 s47, s47, s49
  s_mov_b32 m0, s41
  s_addk_i32 s41, 16384
  buffer_load_dwordx4 v10, s[32:35], s46 offen  lds
  s_addk_i32 m0, 0x1000
  s_addk_i32 s46, 1280
  buffer_load_dwordx4 v10, s[32:35], s46 offen  lds
  s_addk_i32 m0, 0x1000
  s_addk_i32 s46, 1280
  buffer_load_dwordx4 v10, s[32:35], s46 offen  lds
  s_addk_i32 m0, 0x1000
  s_addk_i32 s46, 1280
  buffer_load_dwordx4 v10, s[32:35], s46 offen  lds
  s_addk_i32 s46, 1280
  s_waitcnt vmcnt(9)
  s_barrier
  s_add_u32 m0, s42, s43
  s_add_u32 s43, s43, s48
  buffer_load_dwordx4 v11, s[36:39], s47 offen  lds
  s_addk_i32 m0, 0x1000
  s_and_b32 s43, s43, s50
  buffer_load_dwordx4 v12, s[36:39], s47 offen  lds
  s_addk_i32 m0, 0x1000
  s_nop 0
  buffer_load_dwordx4 v13, s[36:39], s47 offen  lds
  s_addk_i32 m0, 0x1000
  s_nop 0
  buffer_load_dwordx4 v14, s[36:39], s47 offen  lds
  s_add_u32 s47, s47, s49
  s_mov_b32 m0, s41
  s_addk_i32 s41, 16384
  buffer_load_dwordx4 v10, s[32:35], s46 offen  lds
  s_addk_i32 m0, 0x1000
  s_addk_i32 s46, 1280
  buffer_load_dwordx4 v10, s[32:35], s46 offen  lds
  s_addk_i32 m0, 0x1000
  s_addk_i32 s46, 1280
  buffer_load_dwordx4 v10, s[32:35], s46 offen  lds
  s_addk_i32 m0, 0x1000
  s_addk_i32 s46, 1280
  buffer_load_dwordx4 v10, s[32:35], s46 offen  lds
  s_addk_i32 s46, -8832
  s_sub_u32 s44, s41, s51
  s_cselect_b32 s41, s41, s44
  s_add_u32 s53, s53, s55
  buffer_load_dword v21, v20, s[56:59], s53 offen
  s_waitcnt vmcnt(13)
  s_barrier
  s_add_u32 m0, s42, s43
  s_add_u32 s43, s43, s48
  buffer_load_dwordx4 v11, s[36:39], s47 offen  lds
  s_addk_i32 m0, 0x1000
  s_and_b32 s43, s43, s50
  buffer_load_dwordx4 v12, s[36:39], s47 offen  lds
  s_addk_i32 m0, 0x1000
  s_nop 0
  buffer_load_dwordx4 v13, s[36:39], s47 offen  lds
  s_addk_i32 m0, 0x1000
  s_nop 0
  buffer_load_dwordx4 v14, s[36:39], s47 offen  lds
  s_add_u32 s47, s47, s49
  s_mov_b32 m0, s41
  s_addk_i32 s41, 16384
  buffer_load_dwordx4 v10, s[32:35], s46 offen  lds
  s_addk_i32 m0, 0x1000
  s_addk_i32 s46, 1280
  buffer_load_dwordx4 v10, s[32:35], s46 offen  lds
  s_addk_i32 m0, 0x1000
  s_addk_i32 s46, 1280
  buffer_load_dwordx4 v10, s[32:35], s46 offen  lds
  s_addk_i32 m0, 0x1000
  s_addk_i32 s46, 1280
  buffer_load_dwordx4 v10, s[32:35], s46 offen  lds
  s_addk_i32 s46, 1280
  s_waitcnt vmcnt(9)
  s_barrier
  s_add_u32 m0, s42, s43
  s_add_u32 s43, s43, s48
  buffer_load_dwordx4 v11, s[36:39], s47 offen  lds
  s_addk_i32 m0, 0x1000
  s_and_b32 s43, s43, s50
  buffer_load_dwordx4 v12, s[36:39], s47 offen  lds
  s_addk_i32 m0, 0x1000
  s_nop 0
  buffer_load_dwordx4 v13, s[36:39], s47 offen  lds
  s_addk_i32 m0, 0x1000
  s_nop 0
  buffer_load_dwordx4 v14, s[36:39], s47 offen  lds
  s_add_u32 s47, s47, s49
  s_mov_b32 m0, s41
  s_addk_i32 s41, 16384
  buffer_load_dwordx4 v10, s[32:35], s46 offen  lds
  s_addk_i32 m0, 0x1000
  s_addk_i32 s46, 1280
  buffer_load_dwordx4 v10, s[32:35], s46 offen  lds
  s_addk_i32 m0, 0x1000
  s_addk_i32 s46, 1280
  buffer_load_dwordx4 v10, s[32:35], s46 offen  lds
  s_addk_i32 m0, 0x1000
  s_addk_i32 s46, 1280
  buffer_load_dwordx4 v10, s[32:35], s46 offen  lds
  s_addk_i32 s46, -8832
  s_sub_u32 s44, s41, s51
  s_cselect_b32 s41, s41, s44
  s_waitcnt vmcnt(12)
  s_barrier
  s_movk_i32 s45, 5
L_ploop:
  s_add_u32 m0, s42, s43
  s_add_u32 s43, s43, s48
  buffer_load_dwordx4 v11, s[36:39], s47 offen  lds
  s_addk_i32 m0, 0x1000
  s_and_b32 s43, s43, s50
  buffer_load_dwordx4 v12, s[36:39], s47 offen  lds
  s_addk_i32 m0, 0x1000
  s_nop 0
  buffer_load_dwordx4 v13, s[36:39], s47 offen  lds
  s_addk_i32 m0, 0x1000
  s_nop 0
  buffer_load_dwordx4 v14, s[36:39], s47 offen  lds
  s_add_u32 s47, s47, s49
  s_mov_b32 m0, s41
  s_addk_i32 s41, 16384
  buffer_load_dwordx4 v10, s[32:35], s46 offen  lds
  s_addk_i32 m0, 0x1000
  s_addk_i32 s46, 1280
  buffer_load_dwordx4 v10, s[32:35], s46 offen  lds
  s_addk_i32 m0, 0x1000
  s_addk_i32 s46, 1280
  buffer_load_dwordx4 v10, s[32:35], s46 offen  lds
  s_addk_i32 m0, 0x1000
  s_addk_i32 s46, 1280
  buffer_load_dwordx4 v10, s[32:35], s46 offen  lds
  s_addk_i32 s46, 1280
  s_add_u32 s53, s53, s55
  buffer_load_dword v21, v20, s[56:59], s53 offen
  s_waitcnt vmcnt(9)
  s_barrier
  s_add_u32 m0, s42, s43
  s_add_u32 s43, s43, s48
  buffer_load_dwordx4 v11, s[36:39], s47 offen  lds
  s_addk_i32 m0, 0x1000
  s_and_b32 s43, s43, s50
  buffer_load_dwordx4 v12, s[36:39], s47 offen  lds
  s_addk_i32 m0, 0x1000
  s_nop 0
  buffer_load_dwordx4 v13, s[36:39], s47 offen  lds
  s_addk_i32 m0, 0x1000
  s_nop 0
  buffer_load_dwordx4 v14, s[36:39], s47 offen  lds
  s_add_u32 s47, s47, s49
  s_mov_b32 m0, s41
  s_addk_i32 s41, 16384
  buffer_load_dwordx4 v10, s[32:35], s46 offen  lds
  s_addk_i32 m0, 0x1000
  s_addk_i32 s46, 1280
  buffer_load_dwordx4 v10, s[32:35], s46 offen  lds
  s_addk_i32 m0, 0x1000
  s_addk_i32 s46, 1280
  buffer_load_dwordx4 v10, s[32:35], s46 offen  lds
  s_addk_i32 m0, 0x1000
  s_addk_i32 s46, 1280
  buffer_load_dwordx4 v10, s[32:35], s46 offen  lds
  s_addk_i32 s46, -8832
  s_sub_u32 s44, s41, s51
  s_cselect_b32 s41, s41, s44
  s_waitcnt vmcnt(13)
  s_barrier
  s_sub_u32 s45, s45, 1
  s_cmp_lg_u32 s45, 0
  s_cbranch_scc1 L_ploop
  s_add_u32 m0, s42, s43
  s_add_u32 s43, s43, s48
  buffer_load_dwordx4 v11, s[36:39], s47 offen  lds
  s_addk_i32 m0, 0x1000
  s_and_b32 s43, s43, s50
  buffer_load_dwordx4 v12, s[36:39], s47 offen  lds
  s_addk_i32 m0, 0x1000
  s_nop 0
  buffer_load_dwordx4 v13, s[36:39], s47 offen  lds
  s_addk_i32 m0, 0x1000
  s_nop 0
  buffer_load_dwordx4 v14, s[36:39], s47 offen  lds
  s_add_u32 s47, s47, s49
  s_mov_b32 m0, s41
  s_addk_i32 s41, 16384
  buffer_load_dwordx4 v10, s[32:35], s46 offen  lds
  s_addk_i32 m0, 0x1000
  s_addk_i32 s46, 1280
  buffer_load_dwordx4 v10, s[32:35], s46 offen  lds
  s_addk_i32 m0, 0x1000
  s_addk_i32 s46, 1280
  buffer_load_dwordx4 v10, s[32:35], s46 offen  lds
  s_addk_i32 m0, 0x1000
  s_addk_i32 s46, 1280
  buffer_load_dwordx4 v10, s[32:35], s46 offen  lds
  s_addk_i32 s46, 1280
  s_waitcnt vmcnt(8)
  s_barrier
  s_add_u32 m0, s42, s43
  s_add_u32 s43, s43, s48
  buffer_load_dwordx4 v11, s[36:39], s47 offen  lds
  s_addk_i32 m0, 0x1000
  s_and_b32 s43, s43, s50
  buffer_load_dwordx4 v12, s[36:39], s47 offen  lds
  s_addk_i32 m0, 0x1000
  s_nop 0
  buffer_load_dwordx4 v13, s[36:39], s47 offen  lds
  s_addk_i32 m0, 0x1000
  s_nop 0
  buffer_load_dwordx4 v14, s[36:39], s47 offen  lds
  s_add_u32 s47, s47, s49
  s_mov_b32 m0, s41
  s_addk_i32 s41, 16384
  buffer_load_dwordx4 v10, s[32:35], s46 offen  lds
  s_addk_i32 m0, 0x1000
  s_addk_i32 s46, 1280
  buffer_load_dwordx4 v10, s[32:35], s46 offen  lds
  s_addk_i32 m0, 0x1000
  s_addk_i32 s46, 1280
  buffer_load_dwordx4 v10, s[32:35], s46 offen  lds
  s_addk_i32 m0, 0x1000
  s_addk_i32 s46, 1280
  buffer_load_dwordx4 v10, s[32:35], s46 offen  lds
  s_addk_i32 s46, -8832
  s_sub_u32 s44, s41, s51
  s_cselect_b32 s41, s41, s44
  s_waitcnt vmcnt(12)
  s_barrier
  s_add_u32 m0, s42, s43
  s_add_u32 s43, s43, s48
  buffer_load_dwordx4 v11, s[36:39], s47 offen  lds
  s_addk_i32 m0, 0x1000
  s_and_b32 s43, s43, s50
  buffer_load_dwordx4 v12, s[36:39], s47 offen  lds
  s_addk_i32 m0, 0x1000
  s_nop 0
  buffer_load_dwordx4 v13, s[36:39], s47 offen  lds
  s_addk_i32 m0, 0x1000
  s_nop 0
  buffer_load_dwordx4 v14, s[36:39], s47 offen  lds
  s_add_u32 s47, s47, s49
  s_waitcnt vmcnt(4)
  s_barrier
  s_waitcnt vmcnt(0)
  s_barrier
  s_barrier
  s_barrier
  ds_read_b128 v[40:43], v22 offset:0
  ds_read_b128 v[44:47], v23 offset:0
  ds_read_b128 v[48:51], v22 offset:22528
  ds_read_b128 v[52:55], v23 offset:22528
  s_waitcnt lgkmcnt(3)
  buffer_store_dwordx4 v[40:43], v26, s[72:75], s76 offen  nt
  s_waitcnt lgkmcnt(2)
  buffer_store_dwordx4 v[44:47], v27, s[72:75], s76 offen  nt
  s_waitcnt lgkmcnt(1)
  buffer_store_dwordx4 v[48:51], v26, s[72:75], s77 offen  nt
  s_waitcnt lgkmcnt(0)
  buffer_store_dwordx4 v[52:55], v27, s[72:75], s77 offen  nt
  s_barrier
  ds_read_b128 v[56:59], v22 offset:5632
  ds_read_b128 v[60:63], v23 offset:5632
  ds_read_b128 v[64:67], v22 offset:28160
  ds_read_b128 v[68:71], v23 offset:28160
  s_waitcnt lgkmcnt(3)
  buffer_store_dwordx4 v[56:59], v26, s[72:75], s76 offen offset:1280 nt
  s_waitcnt lgkmcnt(2)
  buffer_store_dwordx4 v[60:63], v27, s[72:75], s76 offen offset:1280 nt
  s_waitcnt lgkmcnt(1)
  buffer_store_dwordx4 v[64:67], v26, s[72:75], s77 offen offset:1280 nt
  s_waitcnt lgkmcnt(0)
  buffer_store_dwordx4 v[68:71], v27, s[72:75], s77 offen offset:1280 nt
  s_barrier
  ds_read_b128 v[40:43], v22 offset:11264
  ds_read_b128 v[44:47], v23 offset:11264
  ds_read_b128 v[48:51], v22 offset:33792
  ds_read_b128 v[52:55], v23 offset:33792
  s_waitcnt lgkmcnt(3)
  buffer_store_dwordx4 v[40:43], v26, s[72:75], s76 offen offset:2560 nt
  s_waitcnt lgkmcnt(2)
  buffer_store_dwordx4 v[44:47], v27, s[72:75], s76 offen offset:2560 nt
  s_waitcnt lgkmcnt(1)
  buffer_store_dwordx4 v[48:51], v26, s[72:75], s77 offen offset:2560 nt
  s_waitcnt lgkmcnt(0)
  buffer_store_dwordx4 v[52:55], v27, s[72:75], s77 offen offset:2560 nt
  s_barrier
  ds_read_b128 v[56:59], v22 offset:16896
  ds_read_b128 v[60:63], v23 offset:16896
  ds_read_b128 v[64:67], v22 offset:39424
  ds_read_b128 v[68:71], v23 offset:39424
  s_waitcnt lgkmcnt(3)
  buffer_store_dwordx4 v[56:59], v26, s[72:75], s76 offen offset:3840
  s_waitcnt lgkmcnt(2)
  buffer_store_dwordx4 v[60:63], v27, s[72:75], s76 offen offset:3840
  s_waitcnt lgkmcnt(1)
  buffer_store_dwordx4 v[64:67], v26, s[72:75], s77 offen offset:3840
  s_waitcnt lgkmcnt(0)
  buffer_store_dwordx4 v[68:71], v27, s[72:75], s77 offen offset:3840
L_exit:
  s_endpgm
L_cons_sel:
  s_sub_u32 s23, s23, 4
  v_min_u32 v3, 19, v0
  s_mul_i32 s29, s23, 20
  v_add_u32 v3, s29, v3
  v_lshlrev_b32 v3, 1, v3
  v_add_u32 v3, s27, v3
  s_waitcnt lgkmcnt(0)
  global_load_ushort v136, v3, s[8:9]
  global_load_ushort v137, v3, s[10:11]
  global_load_ushort v138, v3, s[12:13]
  global_load_ushort v139, v3, s[14:15]
  s_bitcmp1_b32 s23, 0
  s_cbranch_scc1 L_cons_hi
  s_branch L_cons_lo
.p2align 12
L_cons_lo:
  s_lshr_b32 s28, s23, 1
  v_and_b32 v1, 15, v0
  v_lshrrev_b32 v2, 4, v0
  v_lshrrev_b32 v3, 1, v1
  v_xor_b32 v3, v3, v2
  v_lshlrev_b32 v3, 4, v3
  v_lshl_add_u32 v3, v1, 7, v3
  s_lshl_b32 s29, s28, 11
  v_add_u32 v160, s29, v3
  v_xor_b32 v161, 64, v160
  v_add_u32 v162, 0x10000, v160
  v_add_u32 v163, 0x10000, v161
  v_lshrrev_b32 v3, 2, v1
  v_lshl_add_u32 v3, v2, 2, v3
  v_mul_u32_u24 v3, 160, v3
  v_and_b32 v4, 3, v1
  v_lshl_add_u32 v3, v4, 3, v3
  v_add_u32 v164, 98304, v3
  s_lshl_b32 s29, s28, 4
  v_add_u32 v3, s29, v1
  v_mul_u32_u24 v3, 176, v3
  v_lshl_add_u32 v165, v2, 3, v3
  v_lshlrev_b32 v3, 4, v2
  v_add_u32 v166, 49152, v3
  v_min_u32 v3, 19, v0
  s_mul_i32 s29, s23, 20
  v_add_u32 v3, s29, v3
  v_lshlrev_b32 v4, 2, v3
  v_add_u32 v167, 49152, v4
  s_cmp_eq_u32 s28, 0
  s_cbranch_scc1 L_pad_lo_1
  s_cmp_eq_u32 s28, 1
  s_branch L_pad_lo_3
L_warm_lo:
  s_cmp_lg_u32 s2, s2
  s_barrier
  ds_read_b64_tr_b16 v[32:33], v164 offset:0
  ds_read_b64_tr_b16 v[34:35], v164 offset:2560
  ds_read_b128 v[0:3], v160 offset:0
  ds_read_b64_tr_b16 v[36:37], v164 offset:32
  ds_read_b64_tr_b16 v[38:39], v164 offset:2592
  ds_read_b128 v[4:7], v160 offset:4096
  ds_read_b64_tr_b16 v[40:41], v164 offset:64
  ds_read_b64_tr_b16 v[42:43], v164 offset:2624
  ds_read_b128 v[8:11], v160 offset:8192
  ds_read_b64_tr_b16 v[44:45], v164 offset:5120
  ds_read_b64_tr_b16 v[46:47], v164 offset:7680
  ds_read_b128 v[12:15], v160 offset:12288
  ds_read_b64_tr_b16 v[48:49], v164 offset:5152
  ds_read_b64_tr_b16 v[50:51], v164 offset:7712
  ds_read_b128 v[16:19], v160 offset:16384
  ds_read_b64_tr_b16 v[52:53], v164 offset:5184
  ds_read_b64_tr_b16 v[54:55], v164 offset:7744
  ds_read_b128 v[20:23], v160 offset:20480
  ds_read_b64_tr_b16 v[56:57], v164 offset:10240
  ds_read_b64_tr_b16 v[58:59], v164 offset:12800
  ds_read_b128 v[24:27], v160 offset:24576
  ds_read_b64_tr_b16 v[60:61], v164 offset:10272
  ds_read_b64_tr_b16 v[62:63], v164 offset:12832
  ds_read_b128 v[28:31], v160 offset:28672
  ds_read_b64_tr_b16 v[64:65], v164 offset:10304
  ds_read_b64_tr_b16 v[66:67], v164 offset:12864
  s_waitcnt lgkmcnt(0)
  v_mfma_f32_16x16x32_bf16 v[176:179], v[44:47], v[0:3], 0
  v_mfma_f32_16x16x32_bf16 v[176:179], v[56:59], v[4:7], v[176:179]
  v_mfma_f32_16x16x32_bf16 v[180:183], v[56:59], v[8:11], 0
  v_mfma_f32_16x16x32_bf16 v[180:183], v[44:47], v[4:7], v[180:183]
  v_mfma_f32_16x16x32_bf16 v[180:183], v[32:35], v[0:3], v[180:183]
  v_mfma_f32_16x16x32_bf16 v[184:187], v[32:35], v[4:7], 0
  v_mfma_f32_16x16x32_bf16 v[184:187], v[44:47], v[8:11], v[184:187]
  v_mfma_f32_16x16x32_bf16 v[184:187], v[56:59], v[12:15], v[184:187]
  v_mfma_f32_16x16x32_bf16 v[188:191], v[56:59], v[16:19], 0
  v_mfma_f32_16x16x32_bf16 v[188:191], v[44:47], v[12:15], v[188:191]
  v_mfma_f32_16x16x32_bf16 v[188:191], v[32:35], v[8:11], v[188:191]
  v_mfma_f32_16x16x32_bf16 v[192:195], v[32:35], v[12:15], 0
  v_mfma_f32_16x16x32_bf16 v[192:195], v[44:47], v[16:19], v[192:195]
  v_mfma_f32_16x16x32_bf16 v[192:195], v[56:59], v[20:23], v[192:195]
  v_mfma_f32_16x16x32_bf16 v[196:199], v[56:59], v[24:27], 0
  v_mfma_f32_16x16x32_bf16 v[196:199], v[44:47], v[20:23], v[196:199]
  v_mfma_f32_16x16x32_bf16 v[196:199], v[32:35], v[16:19], v[196:199]
  v_mfma_f32_16x16x32_bf16 v[200:203], v[32:35], v[20:23], 0
  v_mfma_f32_16x16x32_bf16 v[200:203], v[44:47], v[24:27], v[200:203]
  v_mfma_f32_16x16x32_bf16 v[200:203], v[56:59], v[28:31], v[200:203]
  s_barrier
  v_mfma_f32_16x16x32_bf16 v[204:207], v[44:47], v[28:31], 0
  v_mfma_f32_16x16x32_bf16 v[204:207], v[32:35], v[24:27], v[204:207]
  ds_read_b64_tr_b16 v[100:101], v164 offset:16384
  v_mfma_f32_16x16x32_bf16 v[208:211], v[48:51], v[0:3], 0
  ds_read_b64_tr_b16 v[102:103], v164 offset:18944
  v_mfma_f32_16x16x32_bf16 v[208:211], v[60:63], v[4:7], v[208:211]
  ds_read_b128 v[68:71], v161 offset:0
  v_mfma_f32_16x16x32_bf16 v[212:215], v[60:63], v[8:11], 0
  ds_read_b64_tr_b16 v[104:105], v164 offset:16416
  v_mfma_f32_16x16x32_bf16 v[212:215], v[48:51], v[4:7], v[212:215]
  ds_read_b64_tr_b16 v[106:107], v164 offset:18976
  v_mfma_f32_16x16x32_bf16 v[212:215], v[36:39], v[0:3], v[212:215]
  ds_read_b128 v[72:75], v161 offset:4096
  v_mfma_f32_16x16x32_bf16 v[216:219], v[36:39], v[4:7], 0
  v_mfma_f32_16x16x32_bf16 v[216:219], v[48:51], v[8:11], v[216:219]
  ds_read_b64_tr_b16 v[108:109], v164 offset:16448
  v_mfma_f32_16x16x32_bf16 v[216:219], v[60:63], v[12:15], v[216:219]
  ds_read_b64_tr_b16 v[110:111], v164 offset:19008
  v_mfma_f32_16x16x32_bf16 v[220:223], v[60:63], v[16:19], 0
  ds_read_b128 v[76:79], v161 offset:8192
  v_mfma_f32_16x16x32_bf16 v[220:223], v[48:51], v[12:15], v[220:223]
  ds_read_b64_tr_b16 v[112:113], v164 offset:21504
  v_mfma_f32_16x16x32_bf16 v[220:223], v[36:39], v[8:11], v[220:223]
  ds_read_b64_tr_b16 v[114:115], v164 offset:24064
  v_mfma_f32_16x16x32_bf16 v[224:227], v[36:39], v[12:15], 0
  ds_read_b128 v[80:83], v161 offset:12288
  v_mfma_f32_16x16x32_bf16 v[224:227], v[48:51], v[16:19], v[224:227]
  ds_read_b64_tr_b16 v[116:117], v164 offset:21536
  v_mfma_f32_16x16x32_bf16 v[224:227], v[60:63], v[20:23], v[224:227]
  v_mfma_f32_16x16x32_bf16 v[228:231], v[60:63], v[24:27], 0
  ds_read_b64_tr_b16 v[118:119], v164 offset:24096
  v_mfma_f32_16x16x32_bf16 v[228:231], v[48:51], v[20:23], v[228:231]
  ds_read_b128 v[84:87], v161 offset:16384
  v_mfma_f32_16x16x32_bf16 v[228:231], v[36:39], v[16:19], v[228:231]
  ds_read_b64_tr_b16 v[120:121], v164 offset:21568
  v_mfma_f32_16x16x32_bf16 v[232:235], v[36:39], v[20:23], 0
  ds_read_b64_tr_b16 v[122:123], v164 offset:24128
  v_mfma_f32_16x16x32_bf16 v[232:235], v[48:51], v[24:27], v[232:235]
  ds_read_b128 v[88:91], v161 offset:20480
  v_mfma_f32_16x16x32_bf16 v[232:235], v[60:63], v[28:31], v[232:235]
  ds_read_b64_tr_b16 v[124:125], v164 offset:26624
  v_mfma_f32_16x16x32_bf16 v[236:239], v[48:51], v[28:31], 0
  v_mfma_f32_16x16x32_bf16 v[236:239], v[36:39], v[24:27], v[236:239]
  ds_read_b64_tr_b16 v[126:127], v164 offset:29184
  v_mfma_f32_16x16x32_bf16 v[240:243], v[52:55], v[0:3], 0
  ds_read_b128 v[92:95], v161 offset:24576
  v_mfma_f32_16x16x32_bf16 v[240:243], v[64:67], v[4:7], v[240:243]
  ds_read_b64_tr_b16 v[128:129], v164 offset:26656
  v_mfma_f32_16x16x32_bf16 v[244:247], v[64:67], v[8:11], 0
  ds_read_b64_tr_b16 v[130:131], v164 offset:29216
  v_mfma_f32_16x16x32_bf16 v[244:247], v[52:55], v[4:7], v[244:247]
  ds_read_b128 v[96:99], v161 offset:28672
  v_mfma_f32_16x16x32_bf16 v[244:247], v[40:43], v[0:3], v[244:247]
  ds_read_b64_tr_b16 v[132:133], v164 offset:26688
  v_mfma_f32_16x16x32_bf16 v[248:251], v[40:43], v[4:7], 0
  ds_read_b64_tr_b16 v[134:135], v164 offset:29248
  v_mfma_f32_16x16x32_bf16 v[248:251], v[52:55], v[8:11], v[248:251]
  v_mfma_f32_16x16x32_bf16 v[248:251], v[64:67], v[12:15], v[248:251]
  v_mfma_f32_16x16x32_bf16 v[252:255], v[64:67], v[16:19], 0
  v_mfma_f32_16x16x32_bf16 v[252:255], v[52:55], v[12:15], v[252:255]
  v_mfma_f32_16x16x32_bf16 v[252:255], v[40:43], v[8:11], v[252:255]
  s_waitcnt lgkmcnt(0)
  s_barrier
  v_mfma_f32_16x16x32_bf16 v[176:179], v[112:115], v[68:71], v[176:179]
  v_mfma_f32_16x16x32_bf16 v[176:179], v[124:127], v[72:75], v[176:179]
  ds_read_b64_tr_b16 v[32:33], v164 offset:32768
  v_mfma_f32_16x16x32_bf16 v[180:183], v[124:127], v[76:79], v[180:183]
  v_mfma_f32_16x16x32_bf16 v[180:183], v[112:115], v[72:75], v[180:183]
  ds_read_b64_tr_b16 v[34:35], v164 offset:35328
  v_mfma_f32_16x16x32_bf16 v[180:183], v[100:103], v[68:71], v[180:183]
  v_mfma_f32_16x16x32_bf16 v[184:187], v[100:103], v[72:75], v[184:187]
  ds_read_b128 v[0:3], v160 offset:32768
  v_mfma_f32_16x16x32_bf16 v[184:187], v[112:115], v[76:79], v[184:187]
  v_mfma_f32_16x16x32_bf16 v[184:187], v[124:127], v[80:83], v[184:187]
  ds_read_b64_tr_b16 v[36:37], v164 offset:32800
  v_mfma_f32_16x16x32_bf16 v[188:191], v[124:127], v[84:87], v[188:191]
  v_mfma_f32_16x16x32_bf16 v[188:191], v[112:115], v[80:83], v[188:191]
  ds_read_b64_tr_b16 v[38:39], v164 offset:35360
  v_mfma_f32_16x16x32_bf16 v[188:191], v[100:103], v[76:79], v[188:191]
  v_mfma_f32_16x16x32_bf16 v[192:195], v[100:103], v[80:83], v[192:195]
  ds_read_b128 v[4:7], v160 offset:36864
  v_mfma_f32_16x16x32_bf16 v[192:195], v[112:115], v[84:87], v[192:195]
  ds_read_b64_tr_b16 v[40:41], v164 offset:32832
  v_mfma_f32_16x16x32_bf16 v[192:195], v[124:127], v[88:91], v[192:195]
  v_mfma_f32_16x16x32_bf16 v[196:199], v[124:127], v[92:95], v[196:199]
  ds_read_b64_tr_b16 v[42:43], v164 offset:35392
  v_mfma_f32_16x16x32_bf16 v[196:199], v[112:115], v[88:91], v[196:199]
  v_mfma_f32_16x16x32_bf16 v[196:199], v[100:103], v[84:87], v[196:199]
  ds_read_b128 v[8:11], v160 offset:40960
  v_mfma_f32_16x16x32_bf16 v[200:203], v[100:103], v[88:91], v[200:203]
  v_mfma_f32_16x16x32_bf16 v[200:203], v[112:115], v[92:95], v[200:203]
  ds_read_b64_tr_b16 v[44:45], v164 offset:37888
  v_mfma_f32_16x16x32_bf16 v[200:203], v[124:127], v[96:99], v[200:203]
  v_mfma_f32_16x16x32_bf16 v[204:207], v[112:115], v[96:99], v[204:207]
  ds_read_b64_tr_b16 v[46:47], v164 offset:40448
  v_mfma_f32_16x16x32_bf16 v[204:207], v[100:103], v[92:95], v[204:207]
  v_mfma_f32_16x16x32_bf16 v[208:211], v[116:119], v[68:71], v[208:211]
  ds_read_b128 v[12:15], v160 offset:45056
  v_mfma_f32_16x16x32_bf16 v[208:211], v[128:131], v[72:75], v[208:211]
  ds_read_b64_tr_b16 v[48:49], v164 offset:37920
  v_mfma_f32_16x16x32_bf16 v[212:215], v[128:131], v[76:79], v[212:215]
  v_mfma_f32_16x16x32_bf16 v[212:215], v[116:119], v[72:75], v[212:215]
  ds_read_b64_tr_b16 v[50:51], v164 offset:40480
  v_mfma_f32_16x16x32_bf16 v[212:215], v[104:107], v[68:71], v[212:215]
  v_mfma_f32_16x16x32_bf16 v[216:219], v[104:107], v[72:75], v[216:219]
  ds_read_b128 v[16:19], v160 offset:49152
  v_mfma_f32_16x16x32_bf16 v[216:219], v[116:119], v[76:79], v[216:219]
  v_mfma_f32_16x16x32_bf16 v[216:219], v[128:131], v[80:83], v[216:219]
  ds_read_b64_tr_b16 v[52:53], v164 offset:37952
  v_mfma_f32_16x16x32_bf16 v[220:223], v[128:131], v[84:87], v[220:223]
  v_mfma_f32_16x16x32_bf16 v[220:223], v[116:119], v[80:83], v[220:223]
  ds_read_b64_tr_b16 v[54:55], v164 offset:40512
  v_mfma_f32_16x16x32_bf16 v[220:223], v[104:107], v[76:79], v[220:223]
  v_mfma_f32_16x16x32_bf16 v[224:227], v[104:107], v[80:83], v[224:227]
  ds_read_b128 v[20:23], v160 offset:53248
  v_mfma_f32_16x16x32_bf16 v[224:227], v[116:119], v[84:87], v[224:227]
  v_mfma_f32_16x16x32_bf16 v[224:227], v[128:131], v[88:91], v[224:227]
  ds_read_b64_tr_b16 v[56:57], v164 offset:43008
  v_mfma_f32_16x16x32_bf16 v[228:231], v[128:131], v[92:95], v[228:231]
  ds_read_b64_tr_b16 v[58:59], v164 offset:45568
  v_mfma_f32_16x16x32_bf16 v[228:231], v[116:119], v[88:91], v[228:231]
  v_mfma_f32_16x16x32_bf16 v[228:231], v[104:107], v[84:87], v[228:231]
  ds_read_b128 v[24:27], v160 offset:57344
  v_mfma_f32_16x16x32_bf16 v[232:235], v[104:107], v[88:91], v[232:235]
  v_mfma_f32_16x16x32_bf16 v[232:235], v[116:119], v[92:95], v[232:235]
  ds_read_b64_tr_b16 v[60:61], v164 offset:43040
  v_mfma_f32_16x16x32_bf16 v[232:235], v[128:131], v[96:99], v[232:235]
  v_mfma_f32_16x16x32_bf16 v[236:239], v[116:119], v[96:99], v[236:239]
  ds_read_b64_tr_b16 v[62:63], v164 offset:45600
  v_mfma_f32_16x16x32_bf16 v[236:239], v[104:107], v[92:95], v[236:239]
  v_mfma_f32_16x16x32_bf16 v[240:243], v[120:123], v[68:71], v[240:243]
  ds_read_b128 v[28:31], v160 offset:61440
  v_mfma_f32_16x16x32_bf16 v[240:243], v[132:135], v[72:75], v[240:243]
  v_mfma_f32_16x16x32_bf16 v[244:247], v[132:135], v[76:79], v[244:247]
  ds_read_b64_tr_b16 v[64:65], v164 offset:43072
  v_mfma_f32_16x16x32_bf16 v[244:247], v[120:123], v[72:75], v[244:247]
  ds_read_b64_tr_b16 v[66:67], v164 offset:45632
  v_mfma_f32_16x16x32_bf16 v[244:247], v[108:111], v[68:71], v[244:247]
  v_mfma_f32_16x16x32_bf16 v[248:251], v[108:111], v[72:75], v[248:251]
  v_mfma_f32_16x16x32_bf16 v[248:251], v[120:123], v[76:79], v[248:251]
  v_mfma_f32_16x16x32_bf16 v[248:251], v[132:135], v[80:83], v[248:251]
  v_mfma_f32_16x16x32_bf16 v[252:255], v[132:135], v[84:87], v[252:255]
  v_mfma_f32_16x16x32_bf16 v[252:255], v[120:123], v[80:83], v[252:255]
  v_mfma_f32_16x16x32_bf16 v[252:255], v[108:111], v[76:79], v[252:255]
  s_waitcnt lgkmcnt(0)
  s_barrier
  v_mfma_f32_16x16x32_bf16 v[176:179], v[44:47], v[0:3], v[176:179]
  v_mfma_f32_16x16x32_bf16 v[176:179], v[56:59], v[4:7], v[176:179]
  ds_read_b64_tr_b16 v[100:101], v164 offset:49152
  v_mfma_f32_16x16x32_bf16 v[180:183], v[56:59], v[8:11], v[180:183]
  v_mfma_f32_16x16x32_bf16 v[180:183], v[44:47], v[4:7], v[180:183]
  ds_read_b64_tr_b16 v[102:103], v164 offset:51712
  v_mfma_f32_16x16x32_bf16 v[180:183], v[32:35], v[0:3], v[180:183]
  v_mfma_f32_16x16x32_bf16 v[184:187], v[32:35], v[4:7], v[184:187]
  ds_read_b128 v[68:71], v161 offset:32768
  v_mfma_f32_16x16x32_bf16 v[184:187], v[44:47], v[8:11], v[184:187]
  v_mfma_f32_16x16x32_bf16 v[184:187], v[56:59], v[12:15], v[184:187]
  ds_read_b64_tr_b16 v[104:105], v164 offset:49184
  v_mfma_f32_16x16x32_bf16 v[188:191], v[56:59], v[16:19], v[188:191]
  v_mfma_f32_16x16x32_bf16 v[188:191], v[44:47], v[12:15], v[188:191]
  ds_read_b64_tr_b16 v[106:107], v164 offset:51744
  v_mfma_f32_16x16x32_bf16 v[188:191], v[32:35], v[8:11], v[188:191]
  v_mfma_f32_16x16x32_bf16 v[192:195], v[32:35], v[12:15], v[192:195]
  ds_read_b128 v[72:75], v161 offset:36864
  v_mfma_f32_16x16x32_bf16 v[192:195], v[44:47], v[16:19], v[192:195]
  ds_read_b64_tr_b16 v[108:109], v164 offset:49216
  v_mfma_f32_16x16x32_bf16 v[192:195], v[56:59], v[20:23], v[192:195]
  v_mfma_f32_16x16x32_bf16 v[196:199], v[56:59], v[24:27], v[196:199]
  ds_read_b64_tr_b16 v[110:111], v164 offset:51776
  v_mfma_f32_16x16x32_bf16 v[196:199], v[44:47], v[20:23], v[196:199]
  v_mfma_f32_16x16x32_bf16 v[196:199], v[32:35], v[16:19], v[196:199]
  ds_read_b128 v[76:79], v161 offset:40960
  v_mfma_f32_16x16x32_bf16 v[200:203], v[32:35], v[20:23], v[200:203]
  v_mfma_f32_16x16x32_bf16 v[200:203], v[44:47], v[24:27], v[200:203]
  ds_read_b64_tr_b16 v[112:113], v164 offset:54272
  v_mfma_f32_16x16x32_bf16 v[200:203], v[56:59], v[28:31], v[200:203]
  v_mfma_f32_16x16x32_bf16 v[204:207], v[44:47], v[28:31], v[204:207]
  ds_read_b64_tr_b16 v[114:115], v164 offset:56832
  v_mfma_f32_16x16x32_bf16 v[204:207], v[32:35], v[24:27], v[204:207]
  v_mfma_f32_16x16x32_bf16 v[208:211], v[48:51], v[0:3], v[208:211]
  ds_read_b128 v[80:83], v161 offset:45056
  v_mfma_f32_16x16x32_bf16 v[208:211], v[60:63], v[4:7], v[208:211]
  ds_read_b64_tr_b16 v[116:117], v164 offset:54304
  v_mfma_f32_16x16x32_bf16 v[212:215], v[60:63], v[8:11], v[212:215]
  v_mfma_f32_16x16x32_bf16 v[212:215], v[48:51], v[4:7], v[212:215]
  ds_read_b64_tr_b16 v[118:119], v164 offset:56864
  v_mfma_f32_16x16x32_bf16 v[212:215], v[36:39], v[0:3], v[212:215]
  v_mfma_f32_16x16x32_bf16 v[216:219], v[36:39], v[4:7], v[216:219]
  ds_read_b128 v[84:87], v161 offset:49152
  v_mfma_f32_16x16x32_bf16 v[216:219], v[48:51], v[8:11], v[216:219]
  v_mfma_f32_16x16x32_bf16 v[216:219], v[60:63], v[12:15], v[216:219]
  ds_read_b64_tr_b16 v[120:121], v164 offset:54336
  v_mfma_f32_16x16x32_bf16 v[220:223], v[60:63], v[16:19], v[220:223]
  v_mfma_f32_16x16x32_bf16 v[220:223], v[48:51], v[12:15], v[220:223]
  ds_read_b64_tr_b16 v[122:123], v164 offset:56896
  v_mfma_f32_16x16x32_bf16 v[220:223], v[36:39], v[8:11], v[220:223]
  v_mfma_f32_16x16x32_bf16 v[224:227], v[36:39], v[12:15], v[224:227]
  ds_read_b128 v[88:91], v161 offset:53248
  v_mfma_f32_16x16x32_bf16 v[224:227], v[48:51], v[16:19], v[224:227]
  v_mfma_f32_16x16x32_bf16 v[224:227], v[60:63], v[20:23], v[224:227]
  ds_read_b64_tr_b16 v[124:125], v164 offset:59392
  v_mfma_f32_16x16x32_bf16 v[228:231], v[60:63], v[24:27], v[228:231]
  ds_read_b64_tr_b16 v[126:127], v164 offset:61952
  v_mfma_f32_16x16x32_bf16 v[228:231], v[48:51], v[20:23], v[228:231]
  v_mfma_f32_16x16x32_bf16 v[228:231], v[36:39], v[16:19], v[228:231]
  ds_read_b128 v[92:95], v161 offset:57344
  v_mfma_f32_16x16x32_bf16 v[232:235], v[36:39], v[20:23], v[232:235]
  v_mfma_f32_16x16x32_bf16 v[232:235], v[48:51], v[24:27], v[232:235]
  ds_read_b64_tr_b16 v[128:129], v164 offset:59424
  v_mfma_f32_16x16x32_bf16 v[232:235], v[60:63], v[28:31], v[232:235]
  v_mfma_f32_16x16x32_bf16 v[236:239], v[48:51], v[28:31], v[236:239]
  ds_read_b64_tr_b16 v[130:131], v164 offset:61984
  v_mfma_f32_16x16x32_bf16 v[236:239], v[36:39], v[24:27], v[236:239]
  v_mfma_f32_16x16x32_bf16 v[240:243], v[52:55], v[0:3], v[240:243]
  ds_read_b128 v[96:99], v161 offset:61440
  v_mfma_f32_16x16x32_bf16 v[240:243], v[64:67], v[4:7], v[240:243]
  v_mfma_f32_16x16x32_bf16 v[244:247], v[64:67], v[8:11], v[244:247]
  ds_read_b64_tr_b16 v[132:133], v164 offset:59456
  v_mfma_f32_16x16x32_bf16 v[244:247], v[52:55], v[4:7], v[244:247]
  ds_read_b64_tr_b16 v[134:135], v164 offset:62016
  v_mfma_f32_16x16x32_bf16 v[244:247], v[40:43], v[0:3], v[244:247]
  v_mfma_f32_16x16x32_bf16 v[248:251], v[40:43], v[4:7], v[248:251]
  v_mfma_f32_16x16x32_bf16 v[248:251], v[52:55], v[8:11], v[248:251]
  v_mfma_f32_16x16x32_bf16 v[248:251], v[64:67], v[12:15], v[248:251]
  v_mfma_f32_16x16x32_bf16 v[252:255], v[64:67], v[16:19], v[252:255]
  v_mfma_f32_16x16x32_bf16 v[252:255], v[52:55], v[12:15], v[252:255]
  v_mfma_f32_16x16x32_bf16 v[252:255], v[40:43], v[8:11], v[252:255]
  s_waitcnt lgkmcnt(0)
  s_barrier
  v_mfma_f32_16x16x32_bf16 v[176:179], v[112:115], v[68:71], v[176:179]
  v_mfma_f32_16x16x32_bf16 v[176:179], v[124:127], v[72:75], v[176:179]
  ds_read_b64_tr_b16 v[32:33], v164 offset:0
  v_mfma_f32_16x16x32_bf16 v[180:183], v[124:127], v[76:79], v[180:183]
  v_mfma_f32_16x16x32_bf16 v[180:183], v[112:115], v[72:75], v[180:183]
  ds_read_b64_tr_b16 v[34:35], v164 offset:2560
  v_mfma_f32_16x16x32_bf16 v[180:183], v[100:103], v[68:71], v[180:183]
  v_mfma_f32_16x16x32_bf16 v[184:187], v[100:103], v[72:75], v[184:187]
  ds_read_b128 v[0:3], v162 offset:0
  v_mfma_f32_16x16x32_bf16 v[184:187], v[112:115], v[76:79], v[184:187]
  v_mfma_f32_16x16x32_bf16 v[184:187], v[124:127], v[80:83], v[184:187]
  ds_read_b64_tr_b16 v[36:37], v164 offset:32
  v_mfma_f32_16x16x32_bf16 v[188:191], v[124:127], v[84:87], v[188:191]
  v_mfma_f32_16x16x32_bf16 v[188:191], v[112:115], v[80:83], v[188:191]
  ds_read_b64_tr_b16 v[38:39], v164 offset:2592
  v_mfma_f32_16x16x32_bf16 v[188:191], v[100:103], v[76:79], v[188:191]
  v_mfma_f32_16x16x32_bf16 v[192:195], v[100:103], v[80:83], v[192:195]
  ds_read_b128 v[4:7], v162 offset:4096
  v_mfma_f32_16x16x32_bf16 v[192:195], v[112:115], v[84:87], v[192:195]
  ds_read_b64_tr_b16 v[40:41], v164 offset:64
  v_mfma_f32_16x16x32_bf16 v[192:195], v[124:127], v[88:91], v[192:195]
  v_mfma_f32_16x16x32_bf16 v[196:199], v[124:127], v[92:95], v[196:199]
  ds_read_b64_tr_b16 v[42:43], v164 offset:2624
  v_mfma_f32_16x16x32_bf16 v[196:199], v[112:115], v[88:91], v[196:199]
  v_mfma_f32_16x16x32_bf16 v[196:199], v[100:103], v[84:87], v[196:199]
  ds_read_b128 v[8:11], v162 offset:8192
  v_mfma_f32_16x16x32_bf16 v[200:203], v[100:103], v[88:91], v[200:203]
  v_mfma_f32_16x16x32_bf16 v[200:203], v[112:115], v[92:95], v[200:203]
  ds_read_b64_tr_b16 v[44:45], v164 offset:5120
  v_mfma_f32_16x16x32_bf16 v[200:203], v[124:127], v[96:99], v[200:203]
  v_mfma_f32_16x16x32_bf16 v[204:207], v[112:115], v[96:99], v[204:207]
  ds_read_b64_tr_b16 v[46:47], v164 offset:7680
  v_mfma_f32_16x16x32_bf16 v[204:207], v[100:103], v[92:95], v[204:207]
  v_mfma_f32_16x16x32_bf16 v[208:211], v[116:119], v[68:71], v[208:211]
  ds_read_b128 v[12:15], v162 offset:12288
  v_mfma_f32_16x16x32_bf16 v[208:211], v[128:131], v[72:75], v[208:211]
  ds_read_b64_tr_b16 v[48:49], v164 offset:5152
  v_mfma_f32_16x16x32_bf16 v[212:215], v[128:131], v[76:79], v[212:215]
  v_mfma_f32_16x16x32_bf16 v[212:215], v[116:119], v[72:75], v[212:215]
  ds_read_b64_tr_b16 v[50:51], v164 offset:7712
  v_mfma_f32_16x16x32_bf16 v[212:215], v[104:107], v[68:71], v[212:215]
  v_mfma_f32_16x16x32_bf16 v[216:219], v[104:107], v[72:75], v[216:219]
  ds_read_b128 v[16:19], v162 offset:16384
  v_mfma_f32_16x16x32_bf16 v[216:219], v[116:119], v[76:79], v[216:219]
  v_mfma_f32_16x16x32_bf16 v[216:219], v[128:131], v[80:83], v[216:219]
  ds_read_b64_tr_b16 v[52:53], v164 offset:5184
  v_mfma_f32_16x16x32_bf16 v[220:223], v[128:131], v[84:87], v[220:223]
  v_mfma_f32_16x16x32_bf16 v[220:223], v[116:119], v[80:83], v[220:223]
  ds_read_b64_tr_b16 v[54:55], v164 offset:7744
  v_mfma_f32_16x16x32_bf16 v[220:223], v[104:107], v[76:79], v[220:223]
  v_mfma_f32_16x16x32_bf16 v[224:227], v[104:107], v[80:83], v[224:227]
  ds_read_b128 v[20:23], v162 offset:20480
  v_mfma_f32_16x16x32_bf16 v[224:227], v[116:119], v[84:87], v[224:227]
  v_mfma_f32_16x16x32_bf16 v[224:227], v[128:131], v[88:91], v[224:227]
  ds_read_b64_tr_b16 v[56:57], v164 offset:10240
  v_mfma_f32_16x16x32_bf16 v[228:231], v[128:131], v[92:95], v[228:231]
  ds_read_b64_tr_b16 v[58:59], v164 offset:12800
  v_mfma_f32_16x16x32_bf16 v[228:231], v[116:119], v[88:91], v[228:231]
  v_mfma_f32_16x16x32_bf16 v[228:231], v[104:107], v[84:87], v[228:231]
  ds_read_b128 v[24:27], v162 offset:24576
  v_mfma_f32_16x16x32_bf16 v[232:235], v[104:107], v[88:91], v[232:235]
  v_mfma_f32_16x16x32_bf16 v[232:235], v[116:119], v[92:95], v[232:235]
  ds_read_b64_tr_b16 v[60:61], v164 offset:10272
  v_mfma_f32_16x16x32_bf16 v[232:235], v[128:131], v[96:99], v[232:235]
  v_mfma_f32_16x16x32_bf16 v[236:239], v[116:119], v[96:99], v[236:239]
  ds_read_b64_tr_b16 v[62:63], v164 offset:12832
  v_mfma_f32_16x16x32_bf16 v[236:239], v[104:107], v[92:95], v[236:239]
  v_mfma_f32_16x16x32_bf16 v[240:243], v[120:123], v[68:71], v[240:243]
  ds_read_b128 v[28:31], v162 offset:28672
  v_mfma_f32_16x16x32_bf16 v[240:243], v[132:135], v[72:75], v[240:243]
  v_mfma_f32_16x16x32_bf16 v[244:247], v[132:135], v[76:79], v[244:247]
  ds_read_b64_tr_b16 v[64:65], v164 offset:10304
  v_mfma_f32_16x16x32_bf16 v[244:247], v[120:123], v[72:75], v[244:247]
  ds_read_b64_tr_b16 v[66:67], v164 offset:12864
  v_mfma_f32_16x16x32_bf16 v[244:247], v[108:111], v[68:71], v[244:247]
  v_mfma_f32_16x16x32_bf16 v[248:251], v[108:111], v[72:75], v[248:251]
  v_mfma_f32_16x16x32_bf16 v[248:251], v[120:123], v[76:79], v[248:251]
  v_mfma_f32_16x16x32_bf16 v[248:251], v[132:135], v[80:83], v[248:251]
  v_mfma_f32_16x16x32_bf16 v[252:255], v[132:135], v[84:87], v[252:255]
  v_mfma_f32_16x16x32_bf16 v[252:255], v[120:123], v[80:83], v[252:255]
  v_mfma_f32_16x16x32_bf16 v[252:255], v[108:111], v[76:79], v[252:255]
  s_waitcnt lgkmcnt(0)
  s_barrier
  v_mfma_f32_16x16x32_bf16 v[176:179], v[44:47], v[0:3], v[176:179]
  v_mfma_f32_16x16x32_bf16 v[176:179], v[56:59], v[4:7], v[176:179]
  ds_read_b64_tr_b16 v[100:101], v164 offset:16384
  v_mfma_f32_16x16x32_bf16 v[180:183], v[56:59], v[8:11], v[180:183]
  v_mfma_f32_16x16x32_bf16 v[180:183], v[44:47], v[4:7], v[180:183]
  ds_read_b64_tr_b16 v[102:103], v164 offset:18944
  v_mfma_f32_16x16x32_bf16 v[180:183], v[32:35], v[0:3], v[180:183]
  v_mfma_f32_16x16x32_bf16 v[184:187], v[32:35], v[4:7], v[184:187]
  ds_read_b128 v[68:71], v163 offset:0
  v_mfma_f32_16x16x32_bf16 v[184:187], v[44:47], v[8:11], v[184:187]
  v_mfma_f32_16x16x32_bf16 v[184:187], v[56:59], v[12:15], v[184:187]
  ds_read_b64_tr_b16 v[104:105], v164 offset:16416
  v_mfma_f32_16x16x32_bf16 v[188:191], v[56:59], v[16:19], v[188:191]
  v_mfma_f32_16x16x32_bf16 v[188:191], v[44:47], v[12:15], v[188:191]
  ds_read_b64_tr_b16 v[106:107], v164 offset:18976
  v_mfma_f32_16x16x32_bf16 v[188:191], v[32:35], v[8:11], v[188:191]
  v_mfma_f32_16x16x32_bf16 v[192:195], v[32:35], v[12:15], v[192:195]
  ds_read_b128 v[72:75], v163 offset:4096
  v_mfma_f32_16x16x32_bf16 v[192:195], v[44:47], v[16:19], v[192:195]
  ds_read_b64_tr_b16 v[108:109], v164 offset:16448
  v_mfma_f32_16x16x32_bf16 v[192:195], v[56:59], v[20:23], v[192:195]
  v_mfma_f32_16x16x32_bf16 v[196:199], v[56:59], v[24:27], v[196:199]
  ds_read_b64_tr_b16 v[110:111], v164 offset:19008
  v_mfma_f32_16x16x32_bf16 v[196:199], v[44:47], v[20:23], v[196:199]
  v_mfma_f32_16x16x32_bf16 v[196:199], v[32:35], v[16:19], v[196:199]
  ds_read_b128 v[76:79], v163 offset:8192
  v_mfma_f32_16x16x32_bf16 v[200:203], v[32:35], v[20:23], v[200:203]
  v_mfma_f32_16x16x32_bf16 v[200:203], v[44:47], v[24:27], v[200:203]
  ds_read_b64_tr_b16 v[112:113], v164 offset:21504
  v_mfma_f32_16x16x32_bf16 v[200:203], v[56:59], v[28:31], v[200:203]
  v_mfma_f32_16x16x32_bf16 v[204:207], v[44:47], v[28:31], v[204:207]
  ds_read_b64_tr_b16 v[114:115], v164 offset:24064
  v_mfma_f32_16x16x32_bf16 v[204:207], v[32:35], v[24:27], v[204:207]
  v_mfma_f32_16x16x32_bf16 v[208:211], v[48:51], v[0:3], v[208:211]
  ds_read_b128 v[80:83], v163 offset:12288
  v_mfma_f32_16x16x32_bf16 v[208:211], v[60:63], v[4:7], v[208:211]
  ds_read_b64_tr_b16 v[116:117], v164 offset:21536
  v_mfma_f32_16x16x32_bf16 v[212:215], v[60:63], v[8:11], v[212:215]
  v_mfma_f32_16x16x32_bf16 v[212:215], v[48:51], v[4:7], v[212:215]
  ds_read_b64_tr_b16 v[118:119], v164 offset:24096
  v_mfma_f32_16x16x32_bf16 v[212:215], v[36:39], v[0:3], v[212:215]
  v_mfma_f32_16x16x32_bf16 v[216:219], v[36:39], v[4:7], v[216:219]
  ds_read_b128 v[84:87], v163 offset:16384
  v_mfma_f32_16x16x32_bf16 v[216:219], v[48:51], v[8:11], v[216:219]
  v_mfma_f32_16x16x32_bf16 v[216:219], v[60:63], v[12:15], v[216:219]
  ds_read_b64_tr_b16 v[120:121], v164 offset:21568
  v_mfma_f32_16x16x32_bf16 v[220:223], v[60:63], v[16:19], v[220:223]
  v_mfma_f32_16x16x32_bf16 v[220:223], v[48:51], v[12:15], v[220:223]
  ds_read_b64_tr_b16 v[122:123], v164 offset:24128
  v_mfma_f32_16x16x32_bf16 v[220:223], v[36:39], v[8:11], v[220:223]
  v_mfma_f32_16x16x32_bf16 v[224:227], v[36:39], v[12:15], v[224:227]
  ds_read_b128 v[88:91], v163 offset:20480
  v_mfma_f32_16x16x32_bf16 v[224:227], v[48:51], v[16:19], v[224:227]
  v_mfma_f32_16x16x32_bf16 v[224:227], v[60:63], v[20:23], v[224:227]
  ds_read_b64_tr_b16 v[124:125], v164 offset:26624
  v_mfma_f32_16x16x32_bf16 v[228:231], v[60:63], v[24:27], v[228:231]
  ds_read_b64_tr_b16 v[126:127], v164 offset:29184
  v_mfma_f32_16x16x32_bf16 v[228:231], v[48:51], v[20:23], v[228:231]
  v_mfma_f32_16x16x32_bf16 v[228:231], v[36:39], v[16:19], v[228:231]
  ds_read_b128 v[92:95], v163 offset:24576
  v_mfma_f32_16x16x32_bf16 v[232:235], v[36:39], v[20:23], v[232:235]
  v_mfma_f32_16x16x32_bf16 v[232:235], v[48:51], v[24:27], v[232:235]
  ds_read_b64_tr_b16 v[128:129], v164 offset:26656
  v_mfma_f32_16x16x32_bf16 v[232:235], v[60:63], v[28:31], v[232:235]
  v_mfma_f32_16x16x32_bf16 v[236:239], v[48:51], v[28:31], v[236:239]
  ds_read_b64_tr_b16 v[130:131], v164 offset:29216
  v_mfma_f32_16x16x32_bf16 v[236:239], v[36:39], v[24:27], v[236:239]
  v_mfma_f32_16x16x32_bf16 v[240:243], v[52:55], v[0:3], v[240:243]
  ds_read_b128 v[96:99], v163 offset:28672
  v_mfma_f32_16x16x32_bf16 v[240:243], v[64:67], v[4:7], v[240:243]
  v_mfma_f32_16x16x32_bf16 v[244:247], v[64:67], v[8:11], v[244:247]
  ds_read_b64_tr_b16 v[132:133], v164 offset:26688
  v_mfma_f32_16x16x32_bf16 v[244:247], v[52:55], v[4:7], v[244:247]
  ds_read_b64_tr_b16 v[134:135], v164 offset:29248
  v_mfma_f32_16x16x32_bf16 v[244:247], v[40:43], v[0:3], v[244:247]
  v_mfma_f32_16x16x32_bf16 v[248:251], v[40:43], v[4:7], v[248:251]
  v_mfma_f32_16x16x32_bf16 v[248:251], v[52:55], v[8:11], v[248:251]
  v_mfma_f32_16x16x32_bf16 v[248:251], v[64:67], v[12:15], v[248:251]
  v_mfma_f32_16x16x32_bf16 v[252:255], v[64:67], v[16:19], v[252:255]
  v_mfma_f32_16x16x32_bf16 v[252:255], v[52:55], v[12:15], v[252:255]
  v_mfma_f32_16x16x32_bf16 v[252:255], v[40:43], v[8:11], v[252:255]
  s_waitcnt lgkmcnt(0)
  s_barrier
  v_mfma_f32_16x16x32_bf16 v[176:179], v[112:115], v[68:71], v[176:179]
  v_mfma_f32_16x16x32_bf16 v[176:179], v[124:127], v[72:75], v[176:179]
  ds_read_b64_tr_b16 v[32:33], v164 offset:32768
  v_mfma_f32_16x16x32_bf16 v[180:183], v[124:127], v[76:79], v[180:183]
  v_mfma_f32_16x16x32_bf16 v[180:183], v[112:115], v[72:75], v[180:183]
  ds_read_b64_tr_b16 v[34:35], v164 offset:35328
  v_mfma_f32_16x16x32_bf16 v[180:183], v[100:103], v[68:71], v[180:183]
  v_mfma_f32_16x16x32_bf16 v[184:187], v[100:103], v[72:75], v[184:187]
  ds_read_b128 v[0:3], v160 offset:0
  v_mfma_f32_16x16x32_bf16 v[184:187], v[112:115], v[76:79], v[184:187]
  v_mfma_f32_16x16x32_bf16 v[184:187], v[124:127], v[80:83], v[184:187]
  ds_read_b64_tr_b16 v[36:37], v164 offset:32800
  v_mfma_f32_16x16x32_bf16 v[188:191], v[124:127], v[84:87], v[188:191]
  v_mfma_f32_16x16x32_bf16 v[188:191], v[112:115], v[80:83], v[188:191]
  ds_read_b64_tr_b16 v[38:39], v164 offset:35360
  v_mfma_f32_16x16x32_bf16 v[188:191], v[100:103], v[76:79], v[188:191]
  v_mfma_f32_16x16x32_bf16 v[192:195], v[100:103], v[80:83], v[192:195]
  ds_read_b128 v[4:7], v160 offset:4096
  v_mfma_f32_16x16x32_bf16 v[192:195], v[112:115], v[84:87], v[192:195]
  ds_read_b64_tr_b16 v[40:41], v164 offset:32832
  v_mfma_f32_16x16x32_bf16 v[192:195], v[124:127], v[88:91], v[192:195]
  v_mfma_f32_16x16x32_bf16 v[196:199], v[124:127], v[92:95], v[196:199]
  ds_read_b64_tr_b16 v[42:43], v164 offset:35392
  v_mfma_f32_16x16x32_bf16 v[196:199], v[112:115], v[88:91], v[196:199]
  v_mfma_f32_16x16x32_bf16 v[196:199], v[100:103], v[84:87], v[196:199]
  ds_read_b128 v[8:11], v160 offset:8192
  v_mfma_f32_16x16x32_bf16 v[200:203], v[100:103], v[88:91], v[200:203]
  v_mfma_f32_16x16x32_bf16 v[200:203], v[112:115], v[92:95], v[200:203]
  ds_read_b64_tr_b16 v[44:45], v164 offset:37888
  v_mfma_f32_16x16x32_bf16 v[200:203], v[124:127], v[96:99], v[200:203]
  v_mfma_f32_16x16x32_bf16 v[204:207], v[112:115], v[96:99], v[204:207]
  ds_read_b64_tr_b16 v[46:47], v164 offset:40448
  v_mfma_f32_16x16x32_bf16 v[204:207], v[100:103], v[92:95], v[204:207]
  v_mfma_f32_16x16x32_bf16 v[208:211], v[116:119], v[68:71], v[208:211]
  ds_read_b128 v[12:15], v160 offset:12288
  v_mfma_f32_16x16x32_bf16 v[208:211], v[128:131], v[72:75], v[208:211]
  ds_read_b64_tr_b16 v[48:49], v164 offset:37920
  v_mfma_f32_16x16x32_bf16 v[212:215], v[128:131], v[76:79], v[212:215]
  v_mfma_f32_16x16x32_bf16 v[212:215], v[116:119], v[72:75], v[212:215]
  ds_read_b64_tr_b16 v[50:51], v164 offset:40480
  v_mfma_f32_16x16x32_bf16 v[212:215], v[104:107], v[68:71], v[212:215]
  v_mfma_f32_16x16x32_bf16 v[216:219], v[104:107], v[72:75], v[216:219]
  ds_read_b128 v[16:19], v160 offset:16384
  v_mfma_f32_16x16x32_bf16 v[216:219], v[116:119], v[76:79], v[216:219]
  v_mfma_f32_16x16x32_bf16 v[216:219], v[128:131], v[80:83], v[216:219]
  ds_read_b64_tr_b16 v[52:53], v164 offset:37952
  v_mfma_f32_16x16x32_bf16 v[220:223], v[128:131], v[84:87], v[220:223]
  v_mfma_f32_16x16x32_bf16 v[220:223], v[116:119], v[80:83], v[220:223]
  ds_read_b64_tr_b16 v[54:55], v164 offset:40512
  v_mfma_f32_16x16x32_bf16 v[220:223], v[104:107], v[76:79], v[220:223]
  v_mfma_f32_16x16x32_bf16 v[224:227], v[104:107], v[80:83], v[224:227]
  ds_read_b128 v[20:23], v160 offset:20480
L_pad_lo_1:
  s_cbranch_scc1 L_pad_lo_2
  v_mfma_f32_16x16x32_bf16 v[224:227], v[116:119], v[84:87], v[224:227]
  v_mfma_f32_16x16x32_bf16 v[224:227], v[128:131], v[88:91], v[224:227]
  ds_read_b64_tr_b16 v[56:57], v164 offset:43008
  v_mfma_f32_16x16x32_bf16 v[228:231], v[128:131], v[92:95], v[228:231]
  ds_read_b64_tr_b16 v[58:59], v164 offset:45568
  v_mfma_f32_16x16x32_bf16 v[228:231], v[116:119], v[88:91], v[228:231]
  v_mfma_f32_16x16x32_bf16 v[228:231], v[104:107], v[84:87], v[228:231]
  ds_read_b128 v[24:27], v160 offset:24576
  v_mfma_f32_16x16x32_bf16 v[232:235], v[104:107], v[88:91], v[232:235]
  v_mfma_f32_16x16x32_bf16 v[232:235], v[116:119], v[92:95], v[232:235]
  ds_read_b64_tr_b16 v[60:61], v164 offset:43040
  v_mfma_f32_16x16x32_bf16 v[232:235], v[128:131], v[96:99], v[232:235]
  v_mfma_f32_16x16x32_bf16 v[236:239], v[116:119], v[96:99], v[236:239]
  ds_read_b64_tr_b16 v[62:63], v164 offset:45600
  v_mfma_f32_16x16x32_bf16 v[236:239], v[104:107], v[92:95], v[236:239]
  v_mfma_f32_16x16x32_bf16 v[240:243], v[120:123], v[68:71], v[240:243]
  ds_read_b128 v[28:31], v160 offset:28672
  v_mfma_f32_16x16x32_bf16 v[240:243], v[132:135], v[72:75], v[240:243]
  v_mfma_f32_16x16x32_bf16 v[244:247], v[132:135], v[76:79], v[244:247]
  ds_read_b64_tr_b16 v[64:65], v164 offset:43072
  v_mfma_f32_16x16x32_bf16 v[244:247], v[120:123], v[72:75], v[244:247]
  ds_read_b64_tr_b16 v[66:67], v164 offset:45632
  v_mfma_f32_16x16x32_bf16 v[244:247], v[108:111], v[68:71], v[244:247]
  v_mfma_f32_16x16x32_bf16 v[248:251], v[108:111], v[72:75], v[248:251]
  v_mfma_f32_16x16x32_bf16 v[248:251], v[120:123], v[76:79], v[248:251]
  v_mfma_f32_16x16x32_bf16 v[248:251], v[132:135], v[80:83], v[248:251]
  v_mfma_f32_16x16x32_bf16 v[252:255], v[132:135], v[84:87], v[252:255]
  v_mfma_f32_16x16x32_bf16 v[252:255], v[120:123], v[80:83], v[252:255]
  v_mfma_f32_16x16x32_bf16 v[252:255], v[108:111], v[76:79], v[252:255]
  s_waitcnt lgkmcnt(0)
  s_barrier
  v_mfma_f32_16x16x32_bf16 v[176:179], v[44:47], v[0:3], v[176:179]
  v_mfma_f32_16x16x32_bf16 v[176:179], v[56:59], v[4:7], v[176:179]
  ds_read_b64_tr_b16 v[100:101], v164 offset:49152
  v_mfma_f32_16x16x32_bf16 v[180:183], v[56:59], v[8:11], v[180:183]
  v_mfma_f32_16x16x32_bf16 v[180:183], v[44:47], v[4:7], v[180:183]
  ds_read_b64_tr_b16 v[102:103], v164 offset:51712
  v_mfma_f32_16x16x32_bf16 v[180:183], v[32:35], v[0:3], v[180:183]
  v_mfma_f32_16x16x32_bf16 v[184:187], v[32:35], v[4:7], v[184:187]
  ds_read_b128 v[68:71], v161 offset:0
  v_mfma_f32_16x16x32_bf16 v[184:187], v[44:47], v[8:11], v[184:187]
  v_mfma_f32_16x16x32_bf16 v[184:187], v[56:59], v[12:15], v[184:187]
  ds_read_b64_tr_b16 v[104:105], v164 offset:49184
  v_mfma_f32_16x16x32_bf16 v[188:191], v[56:59], v[16:19], v[188:191]
  v_mfma_f32_16x16x32_bf16 v[188:191], v[44:47], v[12:15], v[188:191]
  ds_read_b64_tr_b16 v[106:107], v164 offset:51744
  v_mfma_f32_16x16x32_bf16 v[188:191], v[32:35], v[8:11], v[188:191]
  v_mfma_f32_16x16x32_bf16 v[192:195], v[32:35], v[12:15], v[192:195]
  ds_read_b128 v[72:75], v161 offset:4096
  v_mfma_f32_16x16x32_bf16 v[192:195], v[44:47], v[16:19], v[192:195]
  ds_read_b64_tr_b16 v[108:109], v164 offset:49216
  v_mfma_f32_16x16x32_bf16 v[192:195], v[56:59], v[20:23], v[192:195]
  v_mfma_f32_16x16x32_bf16 v[196:199], v[56:59], v[24:27], v[196:199]
  ds_read_b64_tr_b16 v[110:111], v164 offset:51776
  v_mfma_f32_16x16x32_bf16 v[196:199], v[44:47], v[20:23], v[196:199]
  v_mfma_f32_16x16x32_bf16 v[196:199], v[32:35], v[16:19], v[196:199]
  ds_read_b128 v[76:79], v161 offset:8192
  v_mfma_f32_16x16x32_bf16 v[200:203], v[32:35], v[20:23], v[200:203]
  v_mfma_f32_16x16x32_bf16 v[200:203], v[44:47], v[24:27], v[200:203]
  ds_read_b64_tr_b16 v[112:113], v164 offset:54272
  v_mfma_f32_16x16x32_bf16 v[200:203], v[56:59], v[28:31], v[200:203]
  v_mfma_f32_16x16x32_bf16 v[204:207], v[44:47], v[28:31], v[204:207]
  ds_read_b64_tr_b16 v[114:115], v164 offset:56832
  v_mfma_f32_16x16x32_bf16 v[204:207], v[32:35], v[24:27], v[204:207]
  v_mfma_f32_16x16x32_bf16 v[208:211], v[48:51], v[0:3], v[208:211]
  ds_read_b128 v[80:83], v161 offset:12288
  v_mfma_f32_16x16x32_bf16 v[208:211], v[60:63], v[4:7], v[208:211]
  ds_read_b64_tr_b16 v[116:117], v164 offset:54304
  v_mfma_f32_16x16x32_bf16 v[212:215], v[60:63], v[8:11], v[212:215]
  v_mfma_f32_16x16x32_bf16 v[212:215], v[48:51], v[4:7], v[212:215]
  ds_read_b64_tr_b16 v[118:119], v164 offset:56864
  v_mfma_f32_16x16x32_bf16 v[212:215], v[36:39], v[0:3], v[212:215]
  v_mfma_f32_16x16x32_bf16 v[216:219], v[36:39], v[4:7], v[216:219]
  ds_read_b128 v[84:87], v161 offset:16384
  v_mfma_f32_16x16x32_bf16 v[216:219], v[48:51], v[8:11], v[216:219]
  v_mfma_f32_16x16x32_bf16 v[216:219], v[60:63], v[12:15], v[216:219]
  ds_read_b64_tr_b16 v[120:121], v164 offset:54336
  v_mfma_f32_16x16x32_bf16 v[220:223], v[60:63], v[16:19], v[220:223]
  v_mfma_f32_16x16x32_bf16 v[220:223], v[48:51], v[12:15], v[220:223]
  ds_read_b64_tr_b16 v[122:123], v164 offset:56896
  v_mfma_f32_16x16x32_bf16 v[220:223], v[36:39], v[8:11], v[220:223]
  v_mfma_f32_16x16x32_bf16 v[224:227], v[36:39], v[12:15], v[224:227]
  ds_read_b128 v[88:91], v161 offset:20480
  v_mfma_f32_16x16x32_bf16 v[224:227], v[48:51], v[16:19], v[224:227]
  v_mfma_f32_16x16x32_bf16 v[224:227], v[60:63], v[20:23], v[224:227]
  ds_read_b64_tr_b16 v[124:125], v164 offset:59392
  v_mfma_f32_16x16x32_bf16 v[228:231], v[60:63], v[24:27], v[228:231]
  ds_read_b64_tr_b16 v[126:127], v164 offset:61952
  v_mfma_f32_16x16x32_bf16 v[228:231], v[48:51], v[20:23], v[228:231]
  v_mfma_f32_16x16x32_bf16 v[228:231], v[36:39], v[16:19], v[228:231]
  ds_read_b128 v[92:95], v161 offset:24576
  v_mfma_f32_16x16x32_bf16 v[232:235], v[36:39], v[20:23], v[232:235]
  v_mfma_f32_16x16x32_bf16 v[232:235], v[48:51], v[24:27], v[232:235]
  ds_read_b64_tr_b16 v[128:129], v164 offset:59424
  v_mfma_f32_16x16x32_bf16 v[232:235], v[60:63], v[28:31], v[232:235]
  v_mfma_f32_16x16x32_bf16 v[236:239], v[48:51], v[28:31], v[236:239]
  ds_read_b64_tr_b16 v[130:131], v164 offset:61984
  v_mfma_f32_16x16x32_bf16 v[236:239], v[36:39], v[24:27], v[236:239]
  v_mfma_f32_16x16x32_bf16 v[240:243], v[52:55], v[0:3], v[240:243]
  ds_read_b128 v[96:99], v161 offset:28672
  v_mfma_f32_16x16x32_bf16 v[240:243], v[64:67], v[4:7], v[240:243]
  v_mfma_f32_16x16x32_bf16 v[244:247], v[64:67], v[8:11], v[244:247]
  ds_read_b64_tr_b16 v[132:133], v164 offset:59456
  v_mfma_f32_16x16x32_bf16 v[244:247], v[52:55], v[4:7], v[244:247]
  ds_read_b64_tr_b16 v[134:135], v164 offset:62016
  v_mfma_f32_16x16x32_bf16 v[244:247], v[40:43], v[0:3], v[244:247]
  v_mfma_f32_16x16x32_bf16 v[248:251], v[40:43], v[4:7], v[248:251]
  v_mfma_f32_16x16x32_bf16 v[248:251], v[52:55], v[8:11], v[248:251]
  v_mfma_f32_16x16x32_bf16 v[248:251], v[64:67], v[12:15], v[248:251]
  v_mfma_f32_16x16x32_bf16 v[252:255], v[64:67], v[16:19], v[252:255]
  v_mfma_f32_16x16x32_bf16 v[252:255], v[52:55], v[12:15], v[252:255]
  v_mfma_f32_16x16x32_bf16 v[252:255], v[40:43], v[8:11], v[252:255]
  s_waitcnt lgkmcnt(0)
  s_barrier
  v_mfma_f32_16x16x32_bf16 v[176:179], v[112:115], v[68:71], v[176:179]
  v_mfma_f32_16x16x32_bf16 v[176:179], v[124:127], v[72:75], v[176:179]
  ds_read_b64_tr_b16 v[32:33], v164 offset:0
  v_mfma_f32_16x16x32_bf16 v[180:183], v[124:127], v[76:79], v[180:183]
  v_mfma_f32_16x16x32_bf16 v[180:183], v[112:115], v[72:75], v[180:183]
  ds_read_b64_tr_b16 v[34:35], v164 offset:2560
  v_mfma_f32_16x16x32_bf16 v[180:183], v[100:103], v[68:71], v[180:183]
  v_mfma_f32_16x16x32_bf16 v[184:187], v[100:103], v[72:75], v[184:187]
  ds_read_b128 v[0:3], v160 offset:32768
  v_mfma_f32_16x16x32_bf16 v[184:187], v[112:115], v[76:79], v[184:187]
  v_mfma_f32_16x16x32_bf16 v[184:187], v[124:127], v[80:83], v[184:187]
  ds_read_b64_tr_b16 v[36:37], v164 offset:32
  v_mfma_f32_16x16x32_bf16 v[188:191], v[124:127], v[84:87], v[188:191]
  v_mfma_f32_16x16x32_bf16 v[188:191], v[112:115], v[80:83], v[188:191]
  ds_read_b64_tr_b16 v[38:39], v164 offset:2592
  v_mfma_f32_16x16x32_bf16 v[188:191], v[100:103], v[76:79], v[188:191]
  v_mfma_f32_16x16x32_bf16 v[192:195], v[100:103], v[80:83], v[192:195]
  ds_read_b128 v[4:7], v160 offset:36864
  v_mfma_f32_16x16x32_bf16 v[192:195], v[112:115], v[84:87], v[192:195]
  ds_read_b64_tr_b16 v[40:41], v164 offset:64
  v_mfma_f32_16x16x32_bf16 v[192:195], v[124:127], v[88:91], v[192:195]
  v_mfma_f32_16x16x32_bf16 v[196:199], v[124:127], v[92:95], v[196:199]
  ds_read_b64_tr_b16 v[42:43], v164 offset:2624
  v_mfma_f32_16x16x32_bf16 v[196:199], v[112:115], v[88:91], v[196:199]
  v_mfma_f32_16x16x32_bf16 v[196:199], v[100:103], v[84:87], v[196:199]
  ds_read_b128 v[8:11], v160 offset:40960
  v_mfma_f32_16x16x32_bf16 v[200:203], v[100:103], v[88:91], v[200:203]
  v_mfma_f32_16x16x32_bf16 v[200:203], v[112:115], v[92:95], v[200:203]
  ds_read_b64_tr_b16 v[44:45], v164 offset:5120
  v_mfma_f32_16x16x32_bf16 v[200:203], v[124:127], v[96:99], v[200:203]
  v_mfma_f32_16x16x32_bf16 v[204:207], v[112:115], v[96:99], v[204:207]
  ds_read_b64_tr_b16 v[46:47], v164 offset:7680
  v_mfma_f32_16x16x32_bf16 v[204:207], v[100:103], v[92:95], v[204:207]
  v_mfma_f32_16x16x32_bf16 v[208:211], v[116:119], v[68:71], v[208:211]
  ds_read_b128 v[12:15], v160 offset:45056
  v_mfma_f32_16x16x32_bf16 v[208:211], v[128:131], v[72:75], v[208:211]
  ds_read_b64_tr_b16 v[48:49], v164 offset:5152
  v_mfma_f32_16x16x32_bf16 v[212:215], v[128:131], v[76:79], v[212:215]
  v_mfma_f32_16x16x32_bf16 v[212:215], v[116:119], v[72:75], v[212:215]
  ds_read_b64_tr_b16 v[50:51], v164 offset:7712
  v_mfma_f32_16x16x32_bf16 v[212:215], v[104:107], v[68:71], v[212:215]
  v_mfma_f32_16x16x32_bf16 v[216:219], v[104:107], v[72:75], v[216:219]
  ds_read_b128 v[16:19], v160 offset:49152
  v_mfma_f32_16x16x32_bf16 v[216:219], v[116:119], v[76:79], v[216:219]
  v_mfma_f32_16x16x32_bf16 v[216:219], v[128:131], v[80:83], v[216:219]
  ds_read_b64_tr_b16 v[52:53], v164 offset:5184
  v_mfma_f32_16x16x32_bf16 v[220:223], v[128:131], v[84:87], v[220:223]
  v_mfma_f32_16x16x32_bf16 v[220:223], v[116:119], v[80:83], v[220:223]
  ds_read_b64_tr_b16 v[54:55], v164 offset:7744
  v_mfma_f32_16x16x32_bf16 v[220:223], v[104:107], v[76:79], v[220:223]
  v_mfma_f32_16x16x32_bf16 v[224:227], v[104:107], v[80:83], v[224:227]
  ds_read_b128 v[20:23], v160 offset:53248
  v_mfma_f32_16x16x32_bf16 v[224:227], v[116:119], v[84:87], v[224:227]
  v_mfma_f32_16x16x32_bf16 v[224:227], v[128:131], v[88:91], v[224:227]
  ds_read_b64_tr_b16 v[56:57], v164 offset:10240
  v_mfma_f32_16x16x32_bf16 v[228:231], v[128:131], v[92:95], v[228:231]
  ds_read_b64_tr_b16 v[58:59], v164 offset:12800
  v_mfma_f32_16x16x32_bf16 v[228:231], v[116:119], v[88:91], v[228:231]
  v_mfma_f32_16x16x32_bf16 v[228:231], v[104:107], v[84:87], v[228:231]
  ds_read_b128 v[24:27], v160 offset:57344
  v_mfma_f32_16x16x32_bf16 v[232:235], v[104:107], v[88:91], v[232:235]
  v_mfma_f32_16x16x32_bf16 v[232:235], v[116:119], v[92:95], v[232:235]
  ds_read_b64_tr_b16 v[60:61], v164 offset:10272
  v_mfma_f32_16x16x32_bf16 v[232:235], v[128:131], v[96:99], v[232:235]
  v_mfma_f32_16x16x32_bf16 v[236:239], v[116:119], v[96:99], v[236:239]
  ds_read_b64_tr_b16 v[62:63], v164 offset:12832
  v_mfma_f32_16x16x32_bf16 v[236:239], v[104:107], v[92:95], v[236:239]
  v_mfma_f32_16x16x32_bf16 v[240:243], v[120:123], v[68:71], v[240:243]
  ds_read_b128 v[28:31], v160 offset:61440
  v_mfma_f32_16x16x32_bf16 v[240:243], v[132:135], v[72:75], v[240:243]
  v_mfma_f32_16x16x32_bf16 v[244:247], v[132:135], v[76:79], v[244:247]
  ds_read_b64_tr_b16 v[64:65], v164 offset:10304
  v_mfma_f32_16x16x32_bf16 v[244:247], v[120:123], v[72:75], v[244:247]
  ds_read_b64_tr_b16 v[66:67], v164 offset:12864
  v_mfma_f32_16x16x32_bf16 v[244:247], v[108:111], v[68:71], v[244:247]
  v_mfma_f32_16x16x32_bf16 v[248:251], v[108:111], v[72:75], v[248:251]
  v_mfma_f32_16x16x32_bf16 v[248:251], v[120:123], v[76:79], v[248:251]
  v_mfma_f32_16x16x32_bf16 v[248:251], v[132:135], v[80:83], v[248:251]
  v_mfma_f32_16x16x32_bf16 v[252:255], v[132:135], v[84:87], v[252:255]
  v_mfma_f32_16x16x32_bf16 v[252:255], v[120:123], v[80:83], v[252:255]
  v_mfma_f32_16x16x32_bf16 v[252:255], v[108:111], v[76:79], v[252:255]
  s_waitcnt lgkmcnt(0)
  s_barrier
  v_mfma_f32_16x16x32_bf16 v[176:179], v[44:47], v[0:3], v[176:179]
  v_mfma_f32_16x16x32_bf16 v[176:179], v[56:59], v[4:7], v[176:179]
  ds_read_b64_tr_b16 v[100:101], v164 offset:16384
  s_waitcnt vmcnt(0)
  v_mfma_f32_16x16x32_bf16 v[180:183], v[56:59], v[8:11], v[180:183]
  v_mfma_f32_16x16x32_bf16 v[180:183], v[44:47], v[4:7], v[180:183]
  ds_read_b64_tr_b16 v[102:103], v164 offset:18944
  v_mfma_f32_16x16x32_bf16 v[180:183], v[32:35], v[0:3], v[180:183]
  v_mfma_f32_16x16x32_bf16 v[184:187], v[32:35], v[4:7], v[184:187]
  ds_read_b128 v[68:71], v161 offset:32768
  v_lshlrev_b32 v136, 16, v136
  v_mfma_f32_16x16x32_bf16 v[184:187], v[44:47], v[8:11], v[184:187]
  v_mfma_f32_16x16x32_bf16 v[184:187], v[56:59], v[12:15], v[184:187]
  ds_read_b64_tr_b16 v[104:105], v164 offset:16416
  v_mfma_f32_16x16x32_bf16 v[188:191], v[56:59], v[16:19], v[188:191]
  v_mfma_f32_16x16x32_bf16 v[188:191], v[44:47], v[12:15], v[188:191]
  ds_read_b64_tr_b16 v[106:107], v164 offset:18976
  v_lshlrev_b32 v137, 16, v137
  v_mfma_f32_16x16x32_bf16 v[188:191], v[32:35], v[8:11], v[188:191]
  v_mfma_f32_16x16x32_bf16 v[192:195], v[32:35], v[12:15], v[192:195]
  ds_read_b128 v[72:75], v161 offset:36864
  v_mfma_f32_16x16x32_bf16 v[192:195], v[44:47], v[16:19], v[192:195]
  ds_read_b64_tr_b16 v[108:109], v164 offset:16448
  v_mfma_f32_16x16x32_bf16 v[192:195], v[56:59], v[20:23], v[192:195]
  v_lshlrev_b32 v138, 16, v138
  v_mfma_f32_16x16x32_bf16 v[196:199], v[56:59], v[24:27], v[196:199]
  ds_read_b64_tr_b16 v[110:111], v164 offset:19008
  v_mfma_f32_16x16x32_bf16 v[196:199], v[44:47], v[20:23], v[196:199]
  v_mfma_f32_16x16x32_bf16 v[196:199], v[32:35], v[16:19], v[196:199]
  ds_read_b128 v[76:79], v161 offset:40960
  v_mfma_f32_16x16x32_bf16 v[200:203], v[32:35], v[20:23], v[200:203]
  v_lshlrev_b32 v139, 16, v139
  v_mfma_f32_16x16x32_bf16 v[200:203], v[44:47], v[24:27], v[200:203]
  ds_read_b64_tr_b16 v[112:113], v164 offset:21504
  v_mfma_f32_16x16x32_bf16 v[200:203], v[56:59], v[28:31], v[200:203]
  v_mfma_f32_16x16x32_bf16 v[204:207], v[44:47], v[28:31], v[204:207]
  ds_read_b64_tr_b16 v[114:115], v164 offset:24064
  v_mfma_f32_16x16x32_bf16 v[204:207], v[32:35], v[24:27], v[204:207]
  v_add_f32 v137, 0x3727c5ac, v137
  v_mfma_f32_16x16x32_bf16 v[208:211], v[48:51], v[0:3], v[208:211]
  ds_read_b128 v[80:83], v161 offset:45056
  v_mfma_f32_16x16x32_bf16 v[208:211], v[60:63], v[4:7], v[208:211]
  ds_read_b64_tr_b16 v[116:117], v164 offset:21536
  v_mfma_f32_16x16x32_bf16 v[212:215], v[60:63], v[8:11], v[212:215]
  v_mfma_f32_16x16x32_bf16 v[212:215], v[48:51], v[4:7], v[212:215]
  ds_read_b64_tr_b16 v[118:119], v164 offset:24096
  v_rsq_f32 v137, v137
  v_mfma_f32_16x16x32_bf16 v[212:215], v[36:39], v[0:3], v[212:215]
  v_mfma_f32_16x16x32_bf16 v[216:219], v[36:39], v[4:7], v[216:219]
  ds_read_b128 v[84:87], v161 offset:49152
  v_mfma_f32_16x16x32_bf16 v[216:219], v[48:51], v[8:11], v[216:219]
  v_mfma_f32_16x16x32_bf16 v[216:219], v[60:63], v[12:15], v[216:219]
  ds_read_b64_tr_b16 v[120:121], v164 offset:21568
  v_mul_f32 v138, 0xbfb8aa3b, v138
  v_mfma_f32_16x16x32_bf16 v[220:223], v[60:63], v[16:19], v[220:223]
  v_mfma_f32_16x16x32_bf16 v[220:223], v[48:51], v[12:15], v[220:223]
  ds_read_b64_tr_b16 v[122:123], v164 offset:24128
  v_mfma_f32_16x16x32_bf16 v[220:223], v[36:39], v[8:11], v[220:223]
  v_mfma_f32_16x16x32_bf16 v[224:227], v[36:39], v[12:15], v[224:227]
  ds_read_b128 v[88:91], v161 offset:53248
  v_mul_f32 v139, 0xbfb8aa3b, v139
  v_mfma_f32_16x16x32_bf16 v[224:227], v[48:51], v[16:19], v[224:227]
  v_mfma_f32_16x16x32_bf16 v[224:227], v[60:63], v[20:23], v[224:227]
  ds_read_b64_tr_b16 v[124:125], v164 offset:26624
  v_mfma_f32_16x16x32_bf16 v[228:231], v[60:63], v[24:27], v[228:231]
  ds_read_b64_tr_b16 v[126:127], v164 offset:29184
  v_mfma_f32_16x16x32_bf16 v[228:231], v[48:51], v[20:23], v[228:231]
  v_mul_f32 v140, v138, v137
  v_mfma_f32_16x16x32_bf16 v[228:231], v[36:39], v[16:19], v[228:231]
  ds_read_b128 v[92:95], v161 offset:57344
  v_mfma_f32_16x16x32_bf16 v[232:235], v[36:39], v[20:23], v[232:235]
  v_mfma_f32_16x16x32_bf16 v[232:235], v[48:51], v[24:27], v[232:235]
  ds_read_b64_tr_b16 v[128:129], v164 offset:26656
  v_mfma_f32_16x16x32_bf16 v[232:235], v[60:63], v[28:31], v[232:235]
  v_fma_f32 v141, -v136, v140, v139
  v_mfma_f32_16x16x32_bf16 v[236:239], v[48:51], v[28:31], v[236:239]
  ds_read_b64_tr_b16 v[130:131], v164 offset:29216
  v_mfma_f32_16x16x32_bf16 v[236:239], v[36:39], v[24:27], v[236:239]
  v_mfma_f32_16x16x32_bf16 v[240:243], v[52:55], v[0:3], v[240:243]
  ds_read_b128 v[96:99], v161 offset:61440
  v_mfma_f32_16x16x32_bf16 v[240:243], v[64:67], v[4:7], v[240:243]
  v_mfma_f32_16x16x32_bf16 v[244:247], v[64:67], v[8:11], v[244:247]
  ds_read_b64_tr_b16 v[132:133], v164 offset:26688
  v_mfma_f32_16x16x32_bf16 v[244:247], v[52:55], v[4:7], v[244:247]
  ds_read_b64_tr_b16 v[134:135], v164 offset:29248
  v_mfma_f32_16x16x32_bf16 v[244:247], v[40:43], v[0:3], v[244:247]
  v_mfma_f32_16x16x32_bf16 v[248:251], v[40:43], v[4:7], v[248:251]
  v_mfma_f32_16x16x32_bf16 v[248:251], v[52:55], v[8:11], v[248:251]
  v_mfma_f32_16x16x32_bf16 v[248:251], v[64:67], v[12:15], v[248:251]
  v_mfma_f32_16x16x32_bf16 v[252:255], v[64:67], v[16:19], v[252:255]
  v_mfma_f32_16x16x32_bf16 v[252:255], v[52:55], v[12:15], v[252:255]
  v_mfma_f32_16x16x32_bf16 v[252:255], v[40:43], v[8:11], v[252:255]
  s_waitcnt lgkmcnt(0)
  s_barrier
  v_mfma_f32_16x16x32_bf16 v[176:179], v[112:115], v[68:71], v[176:179]
  v_mfma_f32_16x16x32_bf16 v[176:179], v[124:127], v[72:75], v[176:179]
  ds_read_b64_tr_b16 v[32:33], v164 offset:32768
  v_mfma_f32_16x16x32_bf16 v[180:183], v[124:127], v[76:79], v[180:183]
  v_mfma_f32_16x16x32_bf16 v[180:183], v[112:115], v[72:75], v[180:183]
  ds_read_b64_tr_b16 v[34:35], v164 offset:35328
  v_mfma_f32_16x16x32_bf16 v[180:183], v[100:103], v[68:71], v[180:183]
  v_mfma_f32_16x16x32_bf16 v[184:187], v[100:103], v[72:75], v[184:187]
  ds_read_b128 v[0:3], v162 offset:0
  v_mfma_f32_16x16x32_bf16 v[184:187], v[112:115], v[76:79], v[184:187]
  v_mfma_f32_16x16x32_bf16 v[184:187], v[124:127], v[80:83], v[184:187]
  ds_read_b64_tr_b16 v[36:37], v164 offset:32800
  v_mfma_f32_16x16x32_bf16 v[188:191], v[124:127], v[84:87], v[188:191]
  v_mfma_f32_16x16x32_bf16 v[188:191], v[112:115], v[80:83], v[188:191]
  ds_read_b64_tr_b16 v[38:39], v164 offset:35360
  v_mfma_f32_16x16x32_bf16 v[188:191], v[100:103], v[76:79], v[188:191]
  v_mfma_f32_16x16x32_bf16 v[192:195], v[100:103], v[80:83], v[192:195]
  ds_read_b128 v[4:7], v162 offset:4096
  v_mfma_f32_16x16x32_bf16 v[192:195], v[112:115], v[84:87], v[192:195]
  ds_read_b64_tr_b16 v[40:41], v164 offset:32832
  v_mfma_f32_16x16x32_bf16 v[192:195], v[124:127], v[88:91], v[192:195]
  v_mfma_f32_16x16x32_bf16 v[196:199], v[124:127], v[92:95], v[196:199]
  ds_read_b64_tr_b16 v[42:43], v164 offset:35392
  v_mfma_f32_16x16x32_bf16 v[196:199], v[112:115], v[88:91], v[196:199]
  v_mfma_f32_16x16x32_bf16 v[196:199], v[100:103], v[84:87], v[196:199]
  ds_read_b128 v[8:11], v162 offset:8192
  v_mfma_f32_16x16x32_bf16 v[200:203], v[100:103], v[88:91], v[200:203]
  v_mfma_f32_16x16x32_bf16 v[200:203], v[112:115], v[92:95], v[200:203]
  ds_read_b64_tr_b16 v[44:45], v164 offset:37888
  v_mfma_f32_16x16x32_bf16 v[200:203], v[124:127], v[96:99], v[200:203]
  v_mfma_f32_16x16x32_bf16 v[204:207], v[112:115], v[96:99], v[204:207]
  ds_read_b64_tr_b16 v[46:47], v164 offset:40448
  v_mfma_f32_16x16x32_bf16 v[204:207], v[100:103], v[92:95], v[204:207]
  v_mfma_f32_16x16x32_bf16 v[208:211], v[116:119], v[68:71], v[208:211]
  ds_read_b128 v[12:15], v162 offset:12288
  v_mfma_f32_16x16x32_bf16 v[208:211], v[128:131], v[72:75], v[208:211]
  ds_read_b64_tr_b16 v[48:49], v164 offset:37920
  v_mfma_f32_16x16x32_bf16 v[212:215], v[128:131], v[76:79], v[212:215]
  v_mfma_f32_16x16x32_bf16 v[212:215], v[116:119], v[72:75], v[212:215]
  ds_read_b64_tr_b16 v[50:51], v164 offset:40480
  v_mfma_f32_16x16x32_bf16 v[212:215], v[104:107], v[68:71], v[212:215]
  v_mfma_f32_16x16x32_bf16 v[216:219], v[104:107], v[72:75], v[216:219]
  ds_read_b128 v[16:19], v162 offset:16384
  v_mfma_f32_16x16x32_bf16 v[216:219], v[116:119], v[76:79], v[216:219]
  v_mfma_f32_16x16x32_bf16 v[216:219], v[128:131], v[80:83], v[216:219]
  ds_read_b64_tr_b16 v[52:53], v164 offset:37952
  v_mfma_f32_16x16x32_bf16 v[220:223], v[128:131], v[84:87], v[220:223]
  v_mfma_f32_16x16x32_bf16 v[220:223], v[116:119], v[80:83], v[220:223]
  ds_read_b64_tr_b16 v[54:55], v164 offset:40512
  v_mfma_f32_16x16x32_bf16 v[220:223], v[104:107], v[76:79], v[220:223]
  v_mfma_f32_16x16x32_bf16 v[224:227], v[104:107], v[80:83], v[224:227]
  ds_read_b128 v[20:23], v162 offset:20480
  v_mfma_f32_16x16x32_bf16 v[224:227], v[116:119], v[84:87], v[224:227]
  v_mfma_f32_16x16x32_bf16 v[224:227], v[128:131], v[88:91], v[224:227]
  ds_read_b64_tr_b16 v[56:57], v164 offset:43008
  v_mfma_f32_16x16x32_bf16 v[228:231], v[128:131], v[92:95], v[228:231]
  ds_read_b64_tr_b16 v[58:59], v164 offset:45568
  v_mfma_f32_16x16x32_bf16 v[228:231], v[116:119], v[88:91], v[228:231]
  v_mfma_f32_16x16x32_bf16 v[228:231], v[104:107], v[84:87], v[228:231]
  ds_read_b128 v[24:27], v162 offset:24576
  v_mfma_f32_16x16x32_bf16 v[232:235], v[104:107], v[88:91], v[232:235]
  v_mfma_f32_16x16x32_bf16 v[232:235], v[116:119], v[92:95], v[232:235]
  ds_read_b64_tr_b16 v[60:61], v164 offset:43040
  v_mfma_f32_16x16x32_bf16 v[232:235], v[128:131], v[96:99], v[232:235]
  v_mfma_f32_16x16x32_bf16 v[236:239], v[116:119], v[96:99], v[236:239]
  ds_read_b64_tr_b16 v[62:63], v164 offset:45600
  v_mfma_f32_16x16x32_bf16 v[236:239], v[104:107], v[92:95], v[236:239]
  v_mfma_f32_16x16x32_bf16 v[240:243], v[120:123], v[68:71], v[240:243]
  ds_read_b128 v[28:31], v162 offset:28672
  v_mfma_f32_16x16x32_bf16 v[240:243], v[132:135], v[72:75], v[240:243]
  v_mfma_f32_16x16x32_bf16 v[244:247], v[132:135], v[76:79], v[244:247]
  ds_read_b64_tr_b16 v[64:65], v164 offset:43072
  v_mfma_f32_16x16x32_bf16 v[244:247], v[120:123], v[72:75], v[244:247]
  ds_read_b64_tr_b16 v[66:67], v164 offset:45632
  v_mfma_f32_16x16x32_bf16 v[244:247], v[108:111], v[68:71], v[244:247]
  v_mfma_f32_16x16x32_bf16 v[248:251], v[108:111], v[72:75], v[248:251]
  v_mfma_f32_16x16x32_bf16 v[248:251], v[120:123], v[76:79], v[248:251]
  v_mfma_f32_16x16x32_bf16 v[248:251], v[132:135], v[80:83], v[248:251]
  v_mfma_f32_16x16x32_bf16 v[252:255], v[132:135], v[84:87], v[252:255]
  v_mfma_f32_16x16x32_bf16 v[252:255], v[120:123], v[80:83], v[252:255]
  v_mfma_f32_16x16x32_bf16 v[252:255], v[108:111], v[76:79], v[252:255]
  s_waitcnt lgkmcnt(0)
  s_barrier
  v_mfma_f32_16x16x32_bf16 v[176:179], v[44:47], v[0:3], v[176:179]
  v_mfma_f32_16x16x32_bf16 v[176:179], v[56:59], v[4:7], v[176:179]
  ds_read_b64_tr_b16 v[100:101], v164 offset:49152
  v_mfma_f32_16x16x32_bf16 v[180:183], v[56:59], v[8:11], v[180:183]
  v_mfma_f32_16x16x32_bf16 v[180:183], v[44:47], v[4:7], v[180:183]
  ds_read_b64_tr_b16 v[102:103], v164 offset:51712
  v_mfma_f32_16x16x32_bf16 v[180:183], v[32:35], v[0:3], v[180:183]
  v_mfma_f32_16x16x32_bf16 v[184:187], v[32:35], v[4:7], v[184:187]
  ds_read_b128 v[68:71], v163 offset:0
  v_mfma_f32_16x16x32_bf16 v[184:187], v[44:47], v[8:11], v[184:187]
  v_mfma_f32_16x16x32_bf16 v[184:187], v[56:59], v[12:15], v[184:187]
  ds_read_b64_tr_b16 v[104:105], v164 offset:49184
  v_mfma_f32_16x16x32_bf16 v[188:191], v[56:59], v[16:19], v[188:191]
  v_mfma_f32_16x16x32_bf16 v[188:191], v[44:47], v[12:15], v[188:191]
  ds_read_b64_tr_b16 v[106:107], v164 offset:51744
  v_mfma_f32_16x16x32_bf16 v[188:191], v[32:35], v[8:11], v[188:191]
  v_mfma_f32_16x16x32_bf16 v[192:195], v[32:35], v[12:15], v[192:195]
  ds_read_b128 v[72:75], v163 offset:4096
  v_mfma_f32_16x16x32_bf16 v[192:195], v[44:47], v[16:19], v[192:195]
  ds_read_b64_tr_b16 v[108:109], v164 offset:49216
  v_mfma_f32_16x16x32_bf16 v[192:195], v[56:59], v[20:23], v[192:195]
  v_mfma_f32_16x16x32_bf16 v[196:199], v[56:59], v[24:27], v[196:199]
  ds_read_b64_tr_b16 v[110:111], v164 offset:51776
  v_mfma_f32_16x16x32_bf16 v[196:199], v[44:47], v[20:23], v[196:199]
  v_mfma_f32_16x16x32_bf16 v[196:199], v[32:35], v[16:19], v[196:199]
  ds_read_b128 v[76:79], v163 offset:8192
  v_mfma_f32_16x16x32_bf16 v[200:203], v[32:35], v[20:23], v[200:203]
  v_mfma_f32_16x16x32_bf16 v[200:203], v[44:47], v[24:27], v[200:203]
  ds_read_b64_tr_b16 v[112:113], v164 offset:54272
  v_mfma_f32_16x16x32_bf16 v[200:203], v[56:59], v[28:31], v[200:203]
  v_mfma_f32_16x16x32_bf16 v[204:207], v[44:47], v[28:31], v[204:207]
  ds_read_b64_tr_b16 v[114:115], v164 offset:56832
  v_mfma_f32_16x16x32_bf16 v[204:207], v[32:35], v[24:27], v[204:207]
  v_mfma_f32_16x16x32_bf16 v[208:211], v[48:51], v[0:3], v[208:211]
  ds_read_b128 v[80:83], v163 offset:12288
  v_mfma_f32_16x16x32_bf16 v[208:211], v[60:63], v[4:7], v[208:211]
  ds_read_b64_tr_b16 v[116:117], v164 offset:54304
  v_mfma_f32_16x16x32_bf16 v[212:215], v[60:63], v[8:11], v[212:215]
  v_mfma_f32_16x16x32_bf16 v[212:215], v[48:51], v[4:7], v[212:215]
  ds_read_b64_tr_b16 v[118:119], v164 offset:56864
  v_mfma_f32_16x16x32_bf16 v[212:215], v[36:39], v[0:3], v[212:215]
  v_mfma_f32_16x16x32_bf16 v[216:219], v[36:39], v[4:7], v[216:219]
  ds_read_b128 v[84:87], v163 offset:16384
  v_mfma_f32_16x16x32_bf16 v[216:219], v[48:51], v[8:11], v[216:219]
  v_mfma_f32_16x16x32_bf16 v[216:219], v[60:63], v[12:15], v[216:219]
  ds_read_b64_tr_b16 v[120:121], v164 offset:54336
  v_mfma_f32_16x16x32_bf16 v[220:223], v[60:63], v[16:19], v[220:223]
  v_mfma_f32_16x16x32_bf16 v[220:223], v[48:51], v[12:15], v[220:223]
  ds_read_b64_tr_b16 v[122:123], v164 offset:56896
  v_mfma_f32_16x16x32_bf16 v[220:223], v[36:39], v[8:11], v[220:223]
  v_mfma_f32_16x16x32_bf16 v[224:227], v[36:39], v[12:15], v[224:227]
  ds_read_b128 v[88:91], v163 offset:20480
  v_mfma_f32_16x16x32_bf16 v[224:227], v[48:51], v[16:19], v[224:227]
  v_mfma_f32_16x16x32_bf16 v[224:227], v[60:63], v[20:23], v[224:227]
  ds_read_b64_tr_b16 v[124:125], v164 offset:59392
  v_mfma_f32_16x16x32_bf16 v[228:231], v[60:63], v[24:27], v[228:231]
  ds_read_b64_tr_b16 v[126:127], v164 offset:61952
  v_mfma_f32_16x16x32_bf16 v[228:231], v[48:51], v[20:23], v[228:231]
  v_mfma_f32_16x16x32_bf16 v[228:231], v[36:39], v[16:19], v[228:231]
  ds_read_b128 v[92:95], v163 offset:24576
  v_mfma_f32_16x16x32_bf16 v[232:235], v[36:39], v[20:23], v[232:235]
  v_mfma_f32_16x16x32_bf16 v[232:235], v[48:51], v[24:27], v[232:235]
  ds_read_b64_tr_b16 v[128:129], v164 offset:59424
  v_mfma_f32_16x16x32_bf16 v[232:235], v[60:63], v[28:31], v[232:235]
  v_mfma_f32_16x16x32_bf16 v[236:239], v[48:51], v[28:31], v[236:239]
  ds_read_b64_tr_b16 v[130:131], v164 offset:61984
  v_mfma_f32_16x16x32_bf16 v[236:239], v[36:39], v[24:27], v[236:239]
  v_mfma_f32_16x16x32_bf16 v[240:243], v[52:55], v[0:3], v[240:243]
  ds_read_b128 v[96:99], v163 offset:28672
  v_mfma_f32_16x16x32_bf16 v[240:243], v[64:67], v[4:7], v[240:243]
  v_mfma_f32_16x16x32_bf16 v[244:247], v[64:67], v[8:11], v[244:247]
  ds_read_b64_tr_b16 v[132:133], v164 offset:59456
  v_mfma_f32_16x16x32_bf16 v[244:247], v[52:55], v[4:7], v[244:247]
  ds_read_b64_tr_b16 v[134:135], v164 offset:62016
  v_mfma_f32_16x16x32_bf16 v[244:247], v[40:43], v[0:3], v[244:247]
  v_mfma_f32_16x16x32_bf16 v[248:251], v[40:43], v[4:7], v[248:251]
  v_mfma_f32_16x16x32_bf16 v[248:251], v[52:55], v[8:11], v[248:251]
  v_mfma_f32_16x16x32_bf16 v[248:251], v[64:67], v[12:15], v[248:251]
  v_mfma_f32_16x16x32_bf16 v[252:255], v[64:67], v[16:19], v[252:255]
  v_mfma_f32_16x16x32_bf16 v[252:255], v[52:55], v[12:15], v[252:255]
  v_mfma_f32_16x16x32_bf16 v[252:255], v[40:43], v[8:11], v[252:255]
  s_waitcnt lgkmcnt(0)
  s_barrier
  v_mfma_f32_16x16x32_bf16 v[176:179], v[112:115], v[68:71], v[176:179]
  v_mfma_f32_16x16x32_bf16 v[176:179], v[124:127], v[72:75], v[176:179]
  ds_read_b64_tr_b16 v[32:33], v164 offset:0
  v_mfma_f32_16x16x32_bf16 v[180:183], v[124:127], v[76:79], v[180:183]
  v_mfma_f32_16x16x32_bf16 v[180:183], v[112:115], v[72:75], v[180:183]
  ds_read_b64_tr_b16 v[34:35], v164 offset:2560
  v_mfma_f32_16x16x32_bf16 v[180:183], v[100:103], v[68:71], v[180:183]
  v_mfma_f32_16x16x32_bf16 v[184:187], v[100:103], v[72:75], v[184:187]
  ds_read_b128 v[0:3], v160 offset:0
  v_mfma_f32_16x16x32_bf16 v[184:187], v[112:115], v[76:79], v[184:187]
  v_mfma_f32_16x16x32_bf16 v[184:187], v[124:127], v[80:83], v[184:187]
  ds_read_b64_tr_b16 v[36:37], v164 offset:32
  v_mfma_f32_16x16x32_bf16 v[188:191], v[124:127], v[84:87], v[188:191]
  v_mfma_f32_16x16x32_bf16 v[188:191], v[112:115], v[80:83], v[188:191]
  ds_read_b64_tr_b16 v[38:39], v164 offset:2592
  v_mfma_f32_16x16x32_bf16 v[188:191], v[100:103], v[76:79], v[188:191]
  v_mfma_f32_16x16x32_bf16 v[192:195], v[100:103], v[80:83], v[192:195]
  ds_read_b128 v[4:7], v160 offset:4096
  v_mfma_f32_16x16x32_bf16 v[192:195], v[112:115], v[84:87], v[192:195]
  ds_read_b64_tr_b16 v[40:41], v164 offset:64
  v_mfma_f32_16x16x32_bf16 v[192:195], v[124:127], v[88:91], v[192:195]
  v_mfma_f32_16x16x32_bf16 v[196:199], v[124:127], v[92:95], v[196:199]
  ds_read_b64_tr_b16 v[42:43], v164 offset:2624
  v_mfma_f32_16x16x32_bf16 v[196:199], v[112:115], v[88:91], v[196:199]
  v_mfma_f32_16x16x32_bf16 v[196:199], v[100:103], v[84:87], v[196:199]
  ds_read_b128 v[8:11], v160 offset:8192
  v_mfma_f32_16x16x32_bf16 v[200:203], v[100:103], v[88:91], v[200:203]
  v_mfma_f32_16x16x32_bf16 v[200:203], v[112:115], v[92:95], v[200:203]
  ds_read_b64_tr_b16 v[44:45], v164 offset:5120
  v_mfma_f32_16x16x32_bf16 v[200:203], v[124:127], v[96:99], v[200:203]
  v_mfma_f32_16x16x32_bf16 v[204:207], v[112:115], v[96:99], v[204:207]
  ds_read_b64_tr_b16 v[46:47], v164 offset:7680
  v_mfma_f32_16x16x32_bf16 v[204:207], v[100:103], v[92:95], v[204:207]
  v_mfma_f32_16x16x32_bf16 v[208:211], v[116:119], v[68:71], v[208:211]
  ds_read_b128 v[12:15], v160 offset:12288
  v_mfma_f32_16x16x32_bf16 v[208:211], v[128:131], v[72:75], v[208:211]
  ds_read_b64_tr_b16 v[48:49], v164 offset:5152
  v_mfma_f32_16x16x32_bf16 v[212:215], v[128:131], v[76:79], v[212:215]
  v_mfma_f32_16x16x32_bf16 v[212:215], v[116:119], v[72:75], v[212:215]
  ds_read_b64_tr_b16 v[50:51], v164 offset:7712
  v_mfma_f32_16x16x32_bf16 v[212:215], v[104:107], v[68:71], v[212:215]
  v_mfma_f32_16x16x32_bf16 v[216:219], v[104:107], v[72:75], v[216:219]
  ds_read_b128 v[16:19], v160 offset:16384
  v_mfma_f32_16x16x32_bf16 v[216:219], v[116:119], v[76:79], v[216:219]
  v_mfma_f32_16x16x32_bf16 v[216:219], v[128:131], v[80:83], v[216:219]
  ds_read_b64_tr_b16 v[52:53], v164 offset:5184
  v_mfma_f32_16x16x32_bf16 v[220:223], v[128:131], v[84:87], v[220:223]
  v_mfma_f32_16x16x32_bf16 v[220:223], v[116:119], v[80:83], v[220:223]
  ds_read_b64_tr_b16 v[54:55], v164 offset:7744
  v_mfma_f32_16x16x32_bf16 v[220:223], v[104:107], v[76:79], v[220:223]
  v_mfma_f32_16x16x32_bf16 v[224:227], v[104:107], v[80:83], v[224:227]
  ds_read_b128 v[20:23], v160 offset:20480
  v_mfma_f32_16x16x32_bf16 v[224:227], v[116:119], v[84:87], v[224:227]
  v_mfma_f32_16x16x32_bf16 v[224:227], v[128:131], v[88:91], v[224:227]
  ds_read_b64_tr_b16 v[56:57], v164 offset:10240
  v_mfma_f32_16x16x32_bf16 v[228:231], v[128:131], v[92:95], v[228:231]
  ds_read_b64_tr_b16 v[58:59], v164 offset:12800
  v_mfma_f32_16x16x32_bf16 v[228:231], v[116:119], v[88:91], v[228:231]
  v_mfma_f32_16x16x32_bf16 v[228:231], v[104:107], v[84:87], v[228:231]
  ds_read_b128 v[24:27], v160 offset:24576
  v_mfma_f32_16x16x32_bf16 v[232:235], v[104:107], v[88:91], v[232:235]
  v_mfma_f32_16x16x32_bf16 v[232:235], v[116:119], v[92:95], v[232:235]
  ds_read_b64_tr_b16 v[60:61], v164 offset:10272
  v_mfma_f32_16x16x32_bf16 v[232:235], v[128:131], v[96:99], v[232:235]
L_pad_lo_2:
  s_cbranch_scc1 L_warm_lo
  v_mfma_f32_16x16x32_bf16 v[236:239], v[116:119], v[96:99], v[236:239]
  ds_read_b64_tr_b16 v[62:63], v164 offset:12832
  v_mfma_f32_16x16x32_bf16 v[236:239], v[104:107], v[92:95], v[236:239]
  v_mfma_f32_16x16x32_bf16 v[240:243], v[120:123], v[68:71], v[240:243]
  ds_read_b128 v[28:31], v160 offset:28672
  v_mfma_f32_16x16x32_bf16 v[240:243], v[132:135], v[72:75], v[240:243]
  v_mfma_f32_16x16x32_bf16 v[244:247], v[132:135], v[76:79], v[244:247]
  ds_read_b64_tr_b16 v[64:65], v164 offset:10304
  v_mfma_f32_16x16x32_bf16 v[244:247], v[120:123], v[72:75], v[244:247]
  ds_read_b64_tr_b16 v[66:67], v164 offset:12864
  v_mfma_f32_16x16x32_bf16 v[244:247], v[108:111], v[68:71], v[244:247]
  v_mfma_f32_16x16x32_bf16 v[248:251], v[108:111], v[72:75], v[248:251]
  v_mfma_f32_16x16x32_bf16 v[248:251], v[120:123], v[76:79], v[248:251]
  v_mfma_f32_16x16x32_bf16 v[248:251], v[132:135], v[80:83], v[248:251]
  v_mfma_f32_16x16x32_bf16 v[252:255], v[132:135], v[84:87], v[252:255]
  v_mfma_f32_16x16x32_bf16 v[252:255], v[120:123], v[80:83], v[252:255]
  v_mfma_f32_16x16x32_bf16 v[252:255], v[108:111], v[76:79], v[252:255]
  s_waitcnt lgkmcnt(0)
  s_barrier
  v_mfma_f32_16x16x32_bf16 v[176:179], v[44:47], v[0:3], v[176:179]
  v_mfma_f32_16x16x32_bf16 v[176:179], v[56:59], v[4:7], v[176:179]
  ds_read_b64_tr_b16 v[100:101], v164 offset:16384
  v_mfma_f32_16x16x32_bf16 v[180:183], v[56:59], v[8:11], v[180:183]
  v_mfma_f32_16x16x32_bf16 v[180:183], v[44:47], v[4:7], v[180:183]
  ds_read_b64_tr_b16 v[102:103], v164 offset:18944
  v_mfma_f32_16x16x32_bf16 v[180:183], v[32:35], v[0:3], v[180:183]
  v_mfma_f32_16x16x32_bf16 v[184:187], v[32:35], v[4:7], v[184:187]
  ds_read_b128 v[68:71], v161 offset:0
  v_mfma_f32_16x16x32_bf16 v[184:187], v[44:47], v[8:11], v[184:187]
  v_mfma_f32_16x16x32_bf16 v[184:187], v[56:59], v[12:15], v[184:187]
  ds_read_b64_tr_b16 v[104:105], v164 offset:16416
  v_mfma_f32_16x16x32_bf16 v[188:191], v[56:59], v[16:19], v[188:191]
  v_mfma_f32_16x16x32_bf16 v[188:191], v[44:47], v[12:15], v[188:191]
  ds_read_b64_tr_b16 v[106:107], v164 offset:18976
  v_mfma_f32_16x16x32_bf16 v[188:191], v[32:35], v[8:11], v[188:191]
  v_mfma_f32_16x16x32_bf16 v[192:195], v[32:35], v[12:15], v[192:195]
  ds_read_b128 v[72:75], v161 offset:4096
  v_mfma_f32_16x16x32_bf16 v[192:195], v[44:47], v[16:19], v[192:195]
  ds_read_b64_tr_b16 v[108:109], v164 offset:16448
  v_mfma_f32_16x16x32_bf16 v[192:195], v[56:59], v[20:23], v[192:195]
  v_mfma_f32_16x16x32_bf16 v[196:199], v[56:59], v[24:27], v[196:199]
  ds_read_b64_tr_b16 v[110:111], v164 offset:19008
  v_mfma_f32_16x16x32_bf16 v[196:199], v[44:47], v[20:23], v[196:199]
  v_mfma_f32_16x16x32_bf16 v[196:199], v[32:35], v[16:19], v[196:199]
  ds_read_b128 v[76:79], v161 offset:8192
  v_mfma_f32_16x16x32_bf16 v[200:203], v[32:35], v[20:23], v[200:203]
  v_mfma_f32_16x16x32_bf16 v[200:203], v[44:47], v[24:27], v[200:203]
  ds_read_b64_tr_b16 v[112:113], v164 offset:21504
  v_mfma_f32_16x16x32_bf16 v[200:203], v[56:59], v[28:31], v[200:203]
  v_mfma_f32_16x16x32_bf16 v[204:207], v[44:47], v[28:31], v[204:207]
  ds_read_b64_tr_b16 v[114:115], v164 offset:24064
  v_mfma_f32_16x16x32_bf16 v[204:207], v[32:35], v[24:27], v[204:207]
  v_mfma_f32_16x16x32_bf16 v[208:211], v[48:51], v[0:3], v[208:211]
  ds_read_b128 v[80:83], v161 offset:12288
  v_mfma_f32_16x16x32_bf16 v[208:211], v[60:63], v[4:7], v[208:211]
  ds_read_b64_tr_b16 v[116:117], v164 offset:21536
  v_mfma_f32_16x16x32_bf16 v[212:215], v[60:63], v[8:11], v[212:215]
  v_mfma_f32_16x16x32_bf16 v[212:215], v[48:51], v[4:7], v[212:215]
  ds_read_b64_tr_b16 v[118:119], v164 offset:24096
  v_mfma_f32_16x16x32_bf16 v[212:215], v[36:39], v[0:3], v[212:215]
  v_mfma_f32_16x16x32_bf16 v[216:219], v[36:39], v[4:7], v[216:219]
  ds_read_b128 v[84:87], v161 offset:16384
  v_mfma_f32_16x16x32_bf16 v[216:219], v[48:51], v[8:11], v[216:219]
  v_mfma_f32_16x16x32_bf16 v[216:219], v[60:63], v[12:15], v[216:219]
  ds_read_b64_tr_b16 v[120:121], v164 offset:21568
  v_mfma_f32_16x16x32_bf16 v[220:223], v[60:63], v[16:19], v[220:223]
  v_mfma_f32_16x16x32_bf16 v[220:223], v[48:51], v[12:15], v[220:223]
  ds_read_b64_tr_b16 v[122:123], v164 offset:24128
  v_mfma_f32_16x16x32_bf16 v[220:223], v[36:39], v[8:11], v[220:223]
  v_mfma_f32_16x16x32_bf16 v[224:227], v[36:39], v[12:15], v[224:227]
  ds_read_b128 v[88:91], v161 offset:20480
  v_mfma_f32_16x16x32_bf16 v[224:227], v[48:51], v[16:19], v[224:227]
  v_mfma_f32_16x16x32_bf16 v[224:227], v[60:63], v[20:23], v[224:227]
  ds_read_b64_tr_b16 v[124:125], v164 offset:26624
  v_mfma_f32_16x16x32_bf16 v[228:231], v[60:63], v[24:27], v[228:231]
  ds_read_b64_tr_b16 v[126:127], v164 offset:29184
  v_mfma_f32_16x16x32_bf16 v[228:231], v[48:51], v[20:23], v[228:231]
  v_mfma_f32_16x16x32_bf16 v[228:231], v[36:39], v[16:19], v[228:231]
  ds_read_b128 v[92:95], v161 offset:24576
  v_mfma_f32_16x16x32_bf16 v[232:235], v[36:39], v[20:23], v[232:235]
  v_mfma_f32_16x16x32_bf16 v[232:235], v[48:51], v[24:27], v[232:235]
  ds_read_b64_tr_b16 v[128:129], v164 offset:26656
  v_mfma_f32_16x16x32_bf16 v[232:235], v[60:63], v[28:31], v[232:235]
  v_mfma_f32_16x16x32_bf16 v[236:239], v[48:51], v[28:31], v[236:239]
  ds_read_b64_tr_b16 v[130:131], v164 offset:29216
  v_mfma_f32_16x16x32_bf16 v[236:239], v[36:39], v[24:27], v[236:239]
  v_mfma_f32_16x16x32_bf16 v[240:243], v[52:55], v[0:3], v[240:243]
  ds_read_b128 v[96:99], v161 offset:28672
  v_mfma_f32_16x16x32_bf16 v[240:243], v[64:67], v[4:7], v[240:243]
  v_mfma_f32_16x16x32_bf16 v[244:247], v[64:67], v[8:11], v[244:247]
  ds_read_b64_tr_b16 v[132:133], v164 offset:26688
  v_mfma_f32_16x16x32_bf16 v[244:247], v[52:55], v[4:7], v[244:247]
  ds_read_b64_tr_b16 v[134:135], v164 offset:29248
  v_mfma_f32_16x16x32_bf16 v[244:247], v[40:43], v[0:3], v[244:247]
  v_mfma_f32_16x16x32_bf16 v[248:251], v[40:43], v[4:7], v[248:251]
  v_mfma_f32_16x16x32_bf16 v[248:251], v[52:55], v[8:11], v[248:251]
  v_mfma_f32_16x16x32_bf16 v[248:251], v[64:67], v[12:15], v[248:251]
  v_mfma_f32_16x16x32_bf16 v[252:255], v[64:67], v[16:19], v[252:255]
  v_mfma_f32_16x16x32_bf16 v[252:255], v[52:55], v[12:15], v[252:255]
  v_mfma_f32_16x16x32_bf16 v[252:255], v[40:43], v[8:11], v[252:255]
  s_waitcnt lgkmcnt(0)
  s_barrier
  v_mfma_f32_16x16x32_bf16 v[176:179], v[112:115], v[68:71], v[176:179]
  v_mfma_f32_16x16x32_bf16 v[176:179], v[124:127], v[72:75], v[176:179]
  ds_read_b64_tr_b16 v[32:33], v164 offset:32768
  v_mfma_f32_16x16x32_bf16 v[180:183], v[124:127], v[76:79], v[180:183]
  v_mfma_f32_16x16x32_bf16 v[180:183], v[112:115], v[72:75], v[180:183]
  ds_read_b64_tr_b16 v[34:35], v164 offset:35328
  v_mfma_f32_16x16x32_bf16 v[180:183], v[100:103], v[68:71], v[180:183]
  v_mfma_f32_16x16x32_bf16 v[184:187], v[100:103], v[72:75], v[184:187]
  ds_read_b128 v[0:3], v160 offset:32768
  v_mfma_f32_16x16x32_bf16 v[184:187], v[112:115], v[76:79], v[184:187]
  v_mfma_f32_16x16x32_bf16 v[184:187], v[124:127], v[80:83], v[184:187]
  ds_read_b64_tr_b16 v[36:37], v164 offset:32800
  v_mfma_f32_16x16x32_bf16 v[188:191], v[124:127], v[84:87], v[188:191]
  v_mfma_f32_16x16x32_bf16 v[188:191], v[112:115], v[80:83], v[188:191]
  ds_read_b64_tr_b16 v[38:39], v164 offset:35360
  v_mfma_f32_16x16x32_bf16 v[188:191], v[100:103], v[76:79], v[188:191]
  v_mfma_f32_16x16x32_bf16 v[192:195], v[100:103], v[80:83], v[192:195]
  ds_read_b128 v[4:7], v160 offset:36864
  v_mfma_f32_16x16x32_bf16 v[192:195], v[112:115], v[84:87], v[192:195]
  ds_read_b64_tr_b16 v[40:41], v164 offset:32832
  v_mfma_f32_16x16x32_bf16 v[192:195], v[124:127], v[88:91], v[192:195]
  v_mfma_f32_16x16x32_bf16 v[196:199], v[124:127], v[92:95], v[196:199]
  ds_read_b64_tr_b16 v[42:43], v164 offset:35392
  v_mfma_f32_16x16x32_bf16 v[196:199], v[112:115], v[88:91], v[196:199]
  v_mfma_f32_16x16x32_bf16 v[196:199], v[100:103], v[84:87], v[196:199]
  ds_read_b128 v[8:11], v160 offset:40960
  v_mfma_f32_16x16x32_bf16 v[200:203], v[100:103], v[88:91], v[200:203]
  v_mfma_f32_16x16x32_bf16 v[200:203], v[112:115], v[92:95], v[200:203]
  ds_read_b64_tr_b16 v[44:45], v164 offset:37888
  v_mfma_f32_16x16x32_bf16 v[200:203], v[124:127], v[96:99], v[200:203]
  v_mfma_f32_16x16x32_bf16 v[204:207], v[112:115], v[96:99], v[204:207]
  ds_read_b64_tr_b16 v[46:47], v164 offset:40448
  v_mfma_f32_16x16x32_bf16 v[204:207], v[100:103], v[92:95], v[204:207]
  v_mfma_f32_16x16x32_bf16 v[208:211], v[116:119], v[68:71], v[208:211]
  ds_read_b128 v[12:15], v160 offset:45056
  v_mfma_f32_16x16x32_bf16 v[208:211], v[128:131], v[72:75], v[208:211]
  ds_read_b64_tr_b16 v[48:49], v164 offset:37920
  v_mfma_f32_16x16x32_bf16 v[212:215], v[128:131], v[76:79], v[212:215]
  v_mfma_f32_16x16x32_bf16 v[212:215], v[116:119], v[72:75], v[212:215]
  ds_read_b64_tr_b16 v[50:51], v164 offset:40480
  v_mfma_f32_16x16x32_bf16 v[212:215], v[104:107], v[68:71], v[212:215]
  v_mfma_f32_16x16x32_bf16 v[216:219], v[104:107], v[72:75], v[216:219]
  ds_read_b128 v[16:19], v160 offset:49152
  v_mfma_f32_16x16x32_bf16 v[216:219], v[116:119], v[76:79], v[216:219]
  v_mfma_f32_16x16x32_bf16 v[216:219], v[128:131], v[80:83], v[216:219]
  ds_read_b64_tr_b16 v[52:53], v164 offset:37952
  v_mfma_f32_16x16x32_bf16 v[220:223], v[128:131], v[84:87], v[220:223]
  v_mfma_f32_16x16x32_bf16 v[220:223], v[116:119], v[80:83], v[220:223]
  ds_read_b64_tr_b16 v[54:55], v164 offset:40512
  v_mfma_f32_16x16x32_bf16 v[220:223], v[104:107], v[76:79], v[220:223]
  v_mfma_f32_16x16x32_bf16 v[224:227], v[104:107], v[80:83], v[224:227]
  ds_read_b128 v[20:23], v160 offset:53248
  v_mfma_f32_16x16x32_bf16 v[224:227], v[116:119], v[84:87], v[224:227]
  v_mfma_f32_16x16x32_bf16 v[224:227], v[128:131], v[88:91], v[224:227]
  ds_read_b64_tr_b16 v[56:57], v164 offset:43008
  v_mfma_f32_16x16x32_bf16 v[228:231], v[128:131], v[92:95], v[228:231]
  ds_read_b64_tr_b16 v[58:59], v164 offset:45568
  v_mfma_f32_16x16x32_bf16 v[228:231], v[116:119], v[88:91], v[228:231]
  v_mfma_f32_16x16x32_bf16 v[228:231], v[104:107], v[84:87], v[228:231]
  ds_read_b128 v[24:27], v160 offset:57344
  v_mfma_f32_16x16x32_bf16 v[232:235], v[104:107], v[88:91], v[232:235]
  v_mfma_f32_16x16x32_bf16 v[232:235], v[116:119], v[92:95], v[232:235]
  ds_read_b64_tr_b16 v[60:61], v164 offset:43040
  v_mfma_f32_16x16x32_bf16 v[232:235], v[128:131], v[96:99], v[232:235]
  v_mfma_f32_16x16x32_bf16 v[236:239], v[116:119], v[96:99], v[236:239]
  ds_read_b64_tr_b16 v[62:63], v164 offset:45600
  v_mfma_f32_16x16x32_bf16 v[236:239], v[104:107], v[92:95], v[236:239]
  v_mfma_f32_16x16x32_bf16 v[240:243], v[120:123], v[68:71], v[240:243]
  ds_read_b128 v[28:31], v160 offset:61440
  v_mfma_f32_16x16x32_bf16 v[240:243], v[132:135], v[72:75], v[240:243]
  v_mfma_f32_16x16x32_bf16 v[244:247], v[132:135], v[76:79], v[244:247]
  ds_read_b64_tr_b16 v[64:65], v164 offset:43072
  v_mfma_f32_16x16x32_bf16 v[244:247], v[120:123], v[72:75], v[244:247]
  ds_read_b64_tr_b16 v[66:67], v164 offset:45632
  v_mfma_f32_16x16x32_bf16 v[244:247], v[108:111], v[68:71], v[244:247]
  v_mfma_f32_16x16x32_bf16 v[248:251], v[108:111], v[72:75], v[248:251]
  v_mfma_f32_16x16x32_bf16 v[248:251], v[120:123], v[76:79], v[248:251]
  v_mfma_f32_16x16x32_bf16 v[248:251], v[132:135], v[80:83], v[248:251]
  v_mfma_f32_16x16x32_bf16 v[252:255], v[132:135], v[84:87], v[252:255]
  v_mfma_f32_16x16x32_bf16 v[252:255], v[120:123], v[80:83], v[252:255]
  v_mfma_f32_16x16x32_bf16 v[252:255], v[108:111], v[76:79], v[252:255]
  s_waitcnt lgkmcnt(0)
  s_barrier
  v_mfma_f32_16x16x32_bf16 v[176:179], v[44:47], v[0:3], v[176:179]
  v_mfma_f32_16x16x32_bf16 v[176:179], v[56:59], v[4:7], v[176:179]
  ds_read_b64_tr_b16 v[100:101], v164 offset:49152
  v_mfma_f32_16x16x32_bf16 v[180:183], v[56:59], v[8:11], v[180:183]
  v_mfma_f32_16x16x32_bf16 v[180:183], v[44:47], v[4:7], v[180:183]
  ds_read_b64_tr_b16 v[102:103], v164 offset:51712
  v_mfma_f32_16x16x32_bf16 v[180:183], v[32:35], v[0:3], v[180:183]
  v_mfma_f32_16x16x32_bf16 v[184:187], v[32:35], v[4:7], v[184:187]
  ds_read_b128 v[68:71], v161 offset:32768
  v_mfma_f32_16x16x32_bf16 v[184:187], v[44:47], v[8:11], v[184:187]
  v_mfma_f32_16x16x32_bf16 v[184:187], v[56:59], v[12:15], v[184:187]
  ds_read_b64_tr_b16 v[104:105], v164 offset:49184
  v_mfma_f32_16x16x32_bf16 v[188:191], v[56:59], v[16:19], v[188:191]
  v_mfma_f32_16x16x32_bf16 v[188:191], v[44:47], v[12:15], v[188:191]
  ds_read_b64_tr_b16 v[106:107], v164 offset:51744
  v_mfma_f32_16x16x32_bf16 v[188:191], v[32:35], v[8:11], v[188:191]
  v_mfma_f32_16x16x32_bf16 v[192:195], v[32:35], v[12:15], v[192:195]
  ds_read_b128 v[72:75], v161 offset:36864
  v_mfma_f32_16x16x32_bf16 v[192:195], v[44:47], v[16:19], v[192:195]
  ds_read_b64_tr_b16 v[108:109], v164 offset:49216
  v_mfma_f32_16x16x32_bf16 v[192:195], v[56:59], v[20:23], v[192:195]
  v_mfma_f32_16x16x32_bf16 v[196:199], v[56:59], v[24:27], v[196:199]
  ds_read_b64_tr_b16 v[110:111], v164 offset:51776
  v_mfma_f32_16x16x32_bf16 v[196:199], v[44:47], v[20:23], v[196:199]
  v_mfma_f32_16x16x32_bf16 v[196:199], v[32:35], v[16:19], v[196:199]
  ds_read_b128 v[76:79], v161 offset:40960
  v_mfma_f32_16x16x32_bf16 v[200:203], v[32:35], v[20:23], v[200:203]
  v_mfma_f32_16x16x32_bf16 v[200:203], v[44:47], v[24:27], v[200:203]
  ds_read_b64_tr_b16 v[112:113], v164 offset:54272
  v_mfma_f32_16x16x32_bf16 v[200:203], v[56:59], v[28:31], v[200:203]
  v_mfma_f32_16x16x32_bf16 v[204:207], v[44:47], v[28:31], v[204:207]
  ds_read_b64_tr_b16 v[114:115], v164 offset:56832
  v_mfma_f32_16x16x32_bf16 v[204:207], v[32:35], v[24:27], v[204:207]
  v_mfma_f32_16x16x32_bf16 v[208:211], v[48:51], v[0:3], v[208:211]
  ds_read_b128 v[80:83], v161 offset:45056
  v_mfma_f32_16x16x32_bf16 v[208:211], v[60:63], v[4:7], v[208:211]
  ds_read_b64_tr_b16 v[116:117], v164 offset:54304
  v_mfma_f32_16x16x32_bf16 v[212:215], v[60:63], v[8:11], v[212:215]
  v_mfma_f32_16x16x32_bf16 v[212:215], v[48:51], v[4:7], v[212:215]
  ds_read_b64_tr_b16 v[118:119], v164 offset:56864
  v_mfma_f32_16x16x32_bf16 v[212:215], v[36:39], v[0:3], v[212:215]
  v_mfma_f32_16x16x32_bf16 v[216:219], v[36:39], v[4:7], v[216:219]
  ds_read_b128 v[84:87], v161 offset:49152
  v_mfma_f32_16x16x32_bf16 v[216:219], v[48:51], v[8:11], v[216:219]
  v_mfma_f32_16x16x32_bf16 v[216:219], v[60:63], v[12:15], v[216:219]
  ds_read_b64_tr_b16 v[120:121], v164 offset:54336
  v_mfma_f32_16x16x32_bf16 v[220:223], v[60:63], v[16:19], v[220:223]
  v_mfma_f32_16x16x32_bf16 v[220:223], v[48:51], v[12:15], v[220:223]
  ds_read_b64_tr_b16 v[122:123], v164 offset:56896
  v_mfma_f32_16x16x32_bf16 v[220:223], v[36:39], v[8:11], v[220:223]
  v_mfma_f32_16x16x32_bf16 v[224:227], v[36:39], v[12:15], v[224:227]
  ds_read_b128 v[88:91], v161 offset:53248
  v_mfma_f32_16x16x32_bf16 v[224:227], v[48:51], v[16:19], v[224:227]
  v_mfma_f32_16x16x32_bf16 v[224:227], v[60:63], v[20:23], v[224:227]
  ds_read_b64_tr_b16 v[124:125], v164 offset:59392
  v_mfma_f32_16x16x32_bf16 v[228:231], v[60:63], v[24:27], v[228:231]
  ds_read_b64_tr_b16 v[126:127], v164 offset:61952
  v_mfma_f32_16x16x32_bf16 v[228:231], v[48:51], v[20:23], v[228:231]
  v_mfma_f32_16x16x32_bf16 v[228:231], v[36:39], v[16:19], v[228:231]
  ds_read_b128 v[92:95], v161 offset:57344
  v_mfma_f32_16x16x32_bf16 v[232:235], v[36:39], v[20:23], v[232:235]
  v_mfma_f32_16x16x32_bf16 v[232:235], v[48:51], v[24:27], v[232:235]
  ds_read_b64_tr_b16 v[128:129], v164 offset:59424
  v_mfma_f32_16x16x32_bf16 v[232:235], v[60:63], v[28:31], v[232:235]
  v_mfma_f32_16x16x32_bf16 v[236:239], v[48:51], v[28:31], v[236:239]
  ds_read_b64_tr_b16 v[130:131], v164 offset:61984
  v_mfma_f32_16x16x32_bf16 v[236:239], v[36:39], v[24:27], v[236:239]
  v_mfma_f32_16x16x32_bf16 v[240:243], v[52:55], v[0:3], v[240:243]
  ds_read_b128 v[96:99], v161 offset:61440
  v_mfma_f32_16x16x32_bf16 v[240:243], v[64:67], v[4:7], v[240:243]
  v_mfma_f32_16x16x32_bf16 v[244:247], v[64:67], v[8:11], v[244:247]
  ds_read_b64_tr_b16 v[132:133], v164 offset:59456
  v_mfma_f32_16x16x32_bf16 v[244:247], v[52:55], v[4:7], v[244:247]
  ds_read_b64_tr_b16 v[134:135], v164 offset:62016
  v_mfma_f32_16x16x32_bf16 v[244:247], v[40:43], v[0:3], v[244:247]
  v_mfma_f32_16x16x32_bf16 v[248:251], v[40:43], v[4:7], v[248:251]
  v_mfma_f32_16x16x32_bf16 v[248:251], v[52:55], v[8:11], v[248:251]
  v_mfma_f32_16x16x32_bf16 v[248:251], v[64:67], v[12:15], v[248:251]
  v_mfma_f32_16x16x32_bf16 v[252:255], v[64:67], v[16:19], v[252:255]
  v_mfma_f32_16x16x32_bf16 v[252:255], v[52:55], v[12:15], v[252:255]
  v_mfma_f32_16x16x32_bf16 v[252:255], v[40:43], v[8:11], v[252:255]
  s_waitcnt lgkmcnt(0)
  s_barrier
  v_mfma_f32_16x16x32_bf16 v[176:179], v[112:115], v[68:71], v[176:179]
  v_mfma_f32_16x16x32_bf16 v[176:179], v[124:127], v[72:75], v[176:179]
  ds_read_b64_tr_b16 v[32:33], v164 offset:0
  v_mfma_f32_16x16x32_bf16 v[180:183], v[124:127], v[76:79], v[180:183]
  v_mfma_f32_16x16x32_bf16 v[180:183], v[112:115], v[72:75], v[180:183]
  ds_read_b64_tr_b16 v[34:35], v164 offset:2560
  v_mfma_f32_16x16x32_bf16 v[180:183], v[100:103], v[68:71], v[180:183]
  v_mfma_f32_16x16x32_bf16 v[184:187], v[100:103], v[72:75], v[184:187]
  ds_read_b128 v[0:3], v162 offset:0
  v_mfma_f32_16x16x32_bf16 v[184:187], v[112:115], v[76:79], v[184:187]
  v_mfma_f32_16x16x32_bf16 v[184:187], v[124:127], v[80:83], v[184:187]
  ds_read_b64_tr_b16 v[36:37], v164 offset:32
  v_mfma_f32_16x16x32_bf16 v[188:191], v[124:127], v[84:87], v[188:191]
  v_mfma_f32_16x16x32_bf16 v[188:191], v[112:115], v[80:83], v[188:191]
  ds_read_b64_tr_b16 v[38:39], v164 offset:2592
  v_mfma_f32_16x16x32_bf16 v[188:191], v[100:103], v[76:79], v[188:191]
  v_mfma_f32_16x16x32_bf16 v[192:195], v[100:103], v[80:83], v[192:195]
  ds_read_b128 v[4:7], v162 offset:4096
  v_mfma_f32_16x16x32_bf16 v[192:195], v[112:115], v[84:87], v[192:195]
  ds_read_b64_tr_b16 v[40:41], v164 offset:64
  v_mfma_f32_16x16x32_bf16 v[192:195], v[124:127], v[88:91], v[192:195]
  v_mfma_f32_16x16x32_bf16 v[196:199], v[124:127], v[92:95], v[196:199]
  ds_read_b64_tr_b16 v[42:43], v164 offset:2624
  v_mfma_f32_16x16x32_bf16 v[196:199], v[112:115], v[88:91], v[196:199]
  v_mfma_f32_16x16x32_bf16 v[196:199], v[100:103], v[84:87], v[196:199]
  ds_read_b128 v[8:11], v162 offset:8192
  v_mfma_f32_16x16x32_bf16 v[200:203], v[100:103], v[88:91], v[200:203]
  v_mfma_f32_16x16x32_bf16 v[200:203], v[112:115], v[92:95], v[200:203]
  ds_read_b64_tr_b16 v[44:45], v164 offset:5120
  v_mfma_f32_16x16x32_bf16 v[200:203], v[124:127], v[96:99], v[200:203]
  v_mfma_f32_16x16x32_bf16 v[204:207], v[112:115], v[96:99], v[204:207]
  ds_read_b64_tr_b16 v[46:47], v164 offset:7680
  v_mfma_f32_16x16x32_bf16 v[204:207], v[100:103], v[92:95], v[204:207]
  v_mfma_f32_16x16x32_bf16 v[208:211], v[116:119], v[68:71], v[208:211]
  ds_read_b128 v[12:15], v162 offset:12288
  v_mfma_f32_16x16x32_bf16 v[208:211], v[128:131], v[72:75], v[208:211]
  ds_read_b64_tr_b16 v[48:49], v164 offset:5152
  v_mfma_f32_16x16x32_bf16 v[212:215], v[128:131], v[76:79], v[212:215]
  v_mfma_f32_16x16x32_bf16 v[212:215], v[116:119], v[72:75], v[212:215]
  ds_read_b64_tr_b16 v[50:51], v164 offset:7712
  v_mfma_f32_16x16x32_bf16 v[212:215], v[104:107], v[68:71], v[212:215]
  v_mfma_f32_16x16x32_bf16 v[216:219], v[104:107], v[72:75], v[216:219]
  ds_read_b128 v[16:19], v162 offset:16384
  v_mfma_f32_16x16x32_bf16 v[216:219], v[116:119], v[76:79], v[216:219]
  v_mfma_f32_16x16x32_bf16 v[216:219], v[128:131], v[80:83], v[216:219]
  ds_read_b64_tr_b16 v[52:53], v164 offset:5184
  v_mfma_f32_16x16x32_bf16 v[220:223], v[128:131], v[84:87], v[220:223]
  v_mfma_f32_16x16x32_bf16 v[220:223], v[116:119], v[80:83], v[220:223]
  ds_read_b64_tr_b16 v[54:55], v164 offset:7744
  v_mfma_f32_16x16x32_bf16 v[220:223], v[104:107], v[76:79], v[220:223]
  v_mfma_f32_16x16x32_bf16 v[224:227], v[104:107], v[80:83], v[224:227]
  ds_read_b128 v[20:23], v162 offset:20480
  v_mfma_f32_16x16x32_bf16 v[224:227], v[116:119], v[84:87], v[224:227]
  v_mfma_f32_16x16x32_bf16 v[224:227], v[128:131], v[88:91], v[224:227]
  ds_read_b64_tr_b16 v[56:57], v164 offset:10240
  v_mfma_f32_16x16x32_bf16 v[228:231], v[128:131], v[92:95], v[228:231]
  ds_read_b64_tr_b16 v[58:59], v164 offset:12800
  v_mfma_f32_16x16x32_bf16 v[228:231], v[116:119], v[88:91], v[228:231]
  v_mfma_f32_16x16x32_bf16 v[228:231], v[104:107], v[84:87], v[228:231]
  ds_read_b128 v[24:27], v162 offset:24576
  v_mfma_f32_16x16x32_bf16 v[232:235], v[104:107], v[88:91], v[232:235]
  v_mfma_f32_16x16x32_bf16 v[232:235], v[116:119], v[92:95], v[232:235]
  ds_read_b64_tr_b16 v[60:61], v164 offset:10272
  v_mfma_f32_16x16x32_bf16 v[232:235], v[128:131], v[96:99], v[232:235]
  v_mfma_f32_16x16x32_bf16 v[236:239], v[116:119], v[96:99], v[236:239]
  ds_read_b64_tr_b16 v[62:63], v164 offset:12832
  v_mfma_f32_16x16x32_bf16 v[236:239], v[104:107], v[92:95], v[236:239]
  v_mfma_f32_16x16x32_bf16 v[240:243], v[120:123], v[68:71], v[240:243]
  ds_read_b128 v[28:31], v162 offset:28672
  v_mfma_f32_16x16x32_bf16 v[240:243], v[132:135], v[72:75], v[240:243]
  v_mfma_f32_16x16x32_bf16 v[244:247], v[132:135], v[76:79], v[244:247]
  ds_read_b64_tr_b16 v[64:65], v164 offset:10304
  v_mfma_f32_16x16x32_bf16 v[244:247], v[120:123], v[72:75], v[244:247]
  ds_read_b64_tr_b16 v[66:67], v164 offset:12864
  v_mfma_f32_16x16x32_bf16 v[244:247], v[108:111], v[68:71], v[244:247]
  v_mfma_f32_16x16x32_bf16 v[248:251], v[108:111], v[72:75], v[248:251]
  v_mfma_f32_16x16x32_bf16 v[248:251], v[120:123], v[76:79], v[248:251]
  v_mfma_f32_16x16x32_bf16 v[248:251], v[132:135], v[80:83], v[248:251]
  v_mfma_f32_16x16x32_bf16 v[252:255], v[132:135], v[84:87], v[252:255]
  v_mfma_f32_16x16x32_bf16 v[252:255], v[120:123], v[80:83], v[252:255]
  v_mfma_f32_16x16x32_bf16 v[252:255], v[108:111], v[76:79], v[252:255]
  s_waitcnt lgkmcnt(0)
  s_barrier
  v_mfma_f32_16x16x32_bf16 v[176:179], v[44:47], v[0:3], v[176:179]
  v_mfma_f32_16x16x32_bf16 v[176:179], v[56:59], v[4:7], v[176:179]
  ds_read_b64_tr_b16 v[100:101], v164 offset:16384
  v_mfma_f32_16x16x32_bf16 v[180:183], v[56:59], v[8:11], v[180:183]
  v_mfma_f32_16x16x32_bf16 v[180:183], v[44:47], v[4:7], v[180:183]
  ds_read_b64_tr_b16 v[102:103], v164 offset:18944
  v_mfma_f32_16x16x32_bf16 v[180:183], v[32:35], v[0:3], v[180:183]
  v_mfma_f32_16x16x32_bf16 v[184:187], v[32:35], v[4:7], v[184:187]
  ds_read_b128 v[68:71], v163 offset:0
  v_mfma_f32_16x16x32_bf16 v[184:187], v[44:47], v[8:11], v[184:187]
  v_mfma_f32_16x16x32_bf16 v[184:187], v[56:59], v[12:15], v[184:187]
  ds_read_b64_tr_b16 v[104:105], v164 offset:16416
  v_mfma_f32_16x16x32_bf16 v[188:191], v[56:59], v[16:19], v[188:191]
  v_mfma_f32_16x16x32_bf16 v[188:191], v[44:47], v[12:15], v[188:191]
  ds_read_b64_tr_b16 v[106:107], v164 offset:18976
  v_mfma_f32_16x16x32_bf16 v[188:191], v[32:35], v[8:11], v[188:191]
  v_mfma_f32_16x16x32_bf16 v[192:195], v[32:35], v[12:15], v[192:195]
  ds_read_b128 v[72:75], v163 offset:4096
  v_mfma_f32_16x16x32_bf16 v[192:195], v[44:47], v[16:19], v[192:195]
  ds_read_b64_tr_b16 v[108:109], v164 offset:16448
  v_mfma_f32_16x16x32_bf16 v[192:195], v[56:59], v[20:23], v[192:195]
  v_mfma_f32_16x16x32_bf16 v[196:199], v[56:59], v[24:27], v[196:199]
  ds_read_b64_tr_b16 v[110:111], v164 offset:19008
  v_mfma_f32_16x16x32_bf16 v[196:199], v[44:47], v[20:23], v[196:199]
  v_mfma_f32_16x16x32_bf16 v[196:199], v[32:35], v[16:19], v[196:199]
  ds_read_b128 v[76:79], v163 offset:8192
  v_mfma_f32_16x16x32_bf16 v[200:203], v[32:35], v[20:23], v[200:203]
  v_mfma_f32_16x16x32_bf16 v[200:203], v[44:47], v[24:27], v[200:203]
  ds_read_b64_tr_b16 v[112:113], v164 offset:21504
  v_mfma_f32_16x16x32_bf16 v[200:203], v[56:59], v[28:31], v[200:203]
  v_mfma_f32_16x16x32_bf16 v[204:207], v[44:47], v[28:31], v[204:207]
  ds_read_b64_tr_b16 v[114:115], v164 offset:24064
  v_mfma_f32_16x16x32_bf16 v[204:207], v[32:35], v[24:27], v[204:207]
  v_mfma_f32_16x16x32_bf16 v[208:211], v[48:51], v[0:3], v[208:211]
  ds_read_b128 v[80:83], v163 offset:12288
  v_mfma_f32_16x16x32_bf16 v[208:211], v[60:63], v[4:7], v[208:211]
  ds_read_b64_tr_b16 v[116:117], v164 offset:21536
  v_mfma_f32_16x16x32_bf16 v[212:215], v[60:63], v[8:11], v[212:215]
  v_mfma_f32_16x16x32_bf16 v[212:215], v[48:51], v[4:7], v[212:215]
  ds_read_b64_tr_b16 v[118:119], v164 offset:24096
  v_mfma_f32_16x16x32_bf16 v[212:215], v[36:39], v[0:3], v[212:215]
  v_mfma_f32_16x16x32_bf16 v[216:219], v[36:39], v[4:7], v[216:219]
  ds_read_b128 v[84:87], v163 offset:16384
  v_mfma_f32_16x16x32_bf16 v[216:219], v[48:51], v[8:11], v[216:219]
  v_mfma_f32_16x16x32_bf16 v[216:219], v[60:63], v[12:15], v[216:219]
  ds_read_b64_tr_b16 v[120:121], v164 offset:21568
  v_mfma_f32_16x16x32_bf16 v[220:223], v[60:63], v[16:19], v[220:223]
  v_mfma_f32_16x16x32_bf16 v[220:223], v[48:51], v[12:15], v[220:223]
  ds_read_b64_tr_b16 v[122:123], v164 offset:24128
  v_mfma_f32_16x16x32_bf16 v[220:223], v[36:39], v[8:11], v[220:223]
  v_mfma_f32_16x16x32_bf16 v[224:227], v[36:39], v[12:15], v[224:227]
  ds_read_b128 v[88:91], v163 offset:20480
  v_mfma_f32_16x16x32_bf16 v[224:227], v[48:51], v[16:19], v[224:227]
  v_mfma_f32_16x16x32_bf16 v[224:227], v[60:63], v[20:23], v[224:227]
  ds_read_b64_tr_b16 v[124:125], v164 offset:26624
  v_mfma_f32_16x16x32_bf16 v[228:231], v[60:63], v[24:27], v[228:231]
  ds_read_b64_tr_b16 v[126:127], v164 offset:29184
  v_mfma_f32_16x16x32_bf16 v[228:231], v[48:51], v[20:23], v[228:231]
  v_mfma_f32_16x16x32_bf16 v[228:231], v[36:39], v[16:19], v[228:231]
  ds_read_b128 v[92:95], v163 offset:24576
  v_mfma_f32_16x16x32_bf16 v[232:235], v[36:39], v[20:23], v[232:235]
  v_mfma_f32_16x16x32_bf16 v[232:235], v[48:51], v[24:27], v[232:235]
  ds_read_b64_tr_b16 v[128:129], v164 offset:26656
  v_mfma_f32_16x16x32_bf16 v[232:235], v[60:63], v[28:31], v[232:235]
  v_mfma_f32_16x16x32_bf16 v[236:239], v[48:51], v[28:31], v[236:239]
  ds_read_b64_tr_b16 v[130:131], v164 offset:29216
  v_mfma_f32_16x16x32_bf16 v[236:239], v[36:39], v[24:27], v[236:239]
  v_mfma_f32_16x16x32_bf16 v[240:243], v[52:55], v[0:3], v[240:243]
  ds_read_b128 v[96:99], v163 offset:28672
  v_mfma_f32_16x16x32_bf16 v[240:243], v[64:67], v[4:7], v[240:243]
  v_mfma_f32_16x16x32_bf16 v[244:247], v[64:67], v[8:11], v[244:247]
  ds_read_b64_tr_b16 v[132:133], v164 offset:26688
  v_mfma_f32_16x16x32_bf16 v[244:247], v[52:55], v[4:7], v[244:247]
  ds_read_b64_tr_b16 v[134:135], v164 offset:29248
  v_mfma_f32_16x16x32_bf16 v[244:247], v[40:43], v[0:3], v[244:247]
  v_mfma_f32_16x16x32_bf16 v[248:251], v[40:43], v[4:7], v[248:251]
  v_mfma_f32_16x16x32_bf16 v[248:251], v[52:55], v[8:11], v[248:251]
  v_mfma_f32_16x16x32_bf16 v[248:251], v[64:67], v[12:15], v[248:251]
  v_mfma_f32_16x16x32_bf16 v[252:255], v[64:67], v[16:19], v[252:255]
  v_mfma_f32_16x16x32_bf16 v[252:255], v[52:55], v[12:15], v[252:255]
  v_mfma_f32_16x16x32_bf16 v[252:255], v[40:43], v[8:11], v[252:255]
  s_waitcnt lgkmcnt(0)
  s_barrier
  v_mfma_f32_16x16x32_bf16 v[176:179], v[112:115], v[68:71], v[176:179]
  v_mfma_f32_16x16x32_bf16 v[176:179], v[124:127], v[72:75], v[176:179]
  ds_read_b64_tr_b16 v[32:33], v164 offset:32768
  v_mfma_f32_16x16x32_bf16 v[180:183], v[124:127], v[76:79], v[180:183]
  v_mfma_f32_16x16x32_bf16 v[180:183], v[112:115], v[72:75], v[180:183]
  ds_read_b64_tr_b16 v[34:35], v164 offset:35328
  v_mfma_f32_16x16x32_bf16 v[180:183], v[100:103], v[68:71], v[180:183]
  v_mfma_f32_16x16x32_bf16 v[184:187], v[100:103], v[72:75], v[184:187]
  ds_read_b128 v[0:3], v160 offset:0
  v_mfma_f32_16x16x32_bf16 v[184:187], v[112:115], v[76:79], v[184:187]
  v_mfma_f32_16x16x32_bf16 v[184:187], v[124:127], v[80:83], v[184:187]
  ds_read_b64_tr_b16 v[36:37], v164 offset:32800
  v_mfma_f32_16x16x32_bf16 v[188:191], v[124:127], v[84:87], v[188:191]
  v_mfma_f32_16x16x32_bf16 v[188:191], v[112:115], v[80:83], v[188:191]
  ds_read_b64_tr_b16 v[38:39], v164 offset:35360
  v_mfma_f32_16x16x32_bf16 v[188:191], v[100:103], v[76:79], v[188:191]
  v_mfma_f32_16x16x32_bf16 v[192:195], v[100:103], v[80:83], v[192:195]
  ds_read_b128 v[4:7], v160 offset:4096
  v_mfma_f32_16x16x32_bf16 v[192:195], v[112:115], v[84:87], v[192:195]
  ds_read_b64_tr_b16 v[40:41], v164 offset:32832
  v_mfma_f32_16x16x32_bf16 v[192:195], v[124:127], v[88:91], v[192:195]
  v_mfma_f32_16x16x32_bf16 v[196:199], v[124:127], v[92:95], v[196:199]
  ds_read_b64_tr_b16 v[42:43], v164 offset:35392
  v_mfma_f32_16x16x32_bf16 v[196:199], v[112:115], v[88:91], v[196:199]
  v_mfma_f32_16x16x32_bf16 v[196:199], v[100:103], v[84:87], v[196:199]
  ds_read_b128 v[8:11], v160 offset:8192
  v_mfma_f32_16x16x32_bf16 v[200:203], v[100:103], v[88:91], v[200:203]
  v_mfma_f32_16x16x32_bf16 v[200:203], v[112:115], v[92:95], v[200:203]
  ds_read_b64_tr_b16 v[44:45], v164 offset:37888
  v_mfma_f32_16x16x32_bf16 v[200:203], v[124:127], v[96:99], v[200:203]
  v_mfma_f32_16x16x32_bf16 v[204:207], v[112:115], v[96:99], v[204:207]
  ds_read_b64_tr_b16 v[46:47], v164 offset:40448
  v_mfma_f32_16x16x32_bf16 v[204:207], v[100:103], v[92:95], v[204:207]
  v_mfma_f32_16x16x32_bf16 v[208:211], v[116:119], v[68:71], v[208:211]
  ds_read_b128 v[12:15], v160 offset:12288
  v_mfma_f32_16x16x32_bf16 v[208:211], v[128:131], v[72:75], v[208:211]
  ds_read_b64_tr_b16 v[48:49], v164 offset:37920
  v_mfma_f32_16x16x32_bf16 v[212:215], v[128:131], v[76:79], v[212:215]
  v_mfma_f32_16x16x32_bf16 v[212:215], v[116:119], v[72:75], v[212:215]
  ds_read_b64_tr_b16 v[50:51], v164 offset:40480
  v_mfma_f32_16x16x32_bf16 v[212:215], v[104:107], v[68:71], v[212:215]
  v_mfma_f32_16x16x32_bf16 v[216:219], v[104:107], v[72:75], v[216:219]
  ds_read_b128 v[16:19], v160 offset:16384
  v_mfma_f32_16x16x32_bf16 v[216:219], v[116:119], v[76:79], v[216:219]
  v_mfma_f32_16x16x32_bf16 v[216:219], v[128:131], v[80:83], v[216:219]
  ds_read_b64_tr_b16 v[52:53], v164 offset:37952
  v_mfma_f32_16x16x32_bf16 v[220:223], v[128:131], v[84:87], v[220:223]
  v_mfma_f32_16x16x32_bf16 v[220:223], v[116:119], v[80:83], v[220:223]
  ds_read_b64_tr_b16 v[54:55], v164 offset:40512
  v_mfma_f32_16x16x32_bf16 v[220:223], v[104:107], v[76:79], v[220:223]
  v_mfma_f32_16x16x32_bf16 v[224:227], v[104:107], v[80:83], v[224:227]
  ds_read_b128 v[20:23], v160 offset:20480
  v_mfma_f32_16x16x32_bf16 v[224:227], v[116:119], v[84:87], v[224:227]
  v_mfma_f32_16x16x32_bf16 v[224:227], v[128:131], v[88:91], v[224:227]
  ds_read_b64_tr_b16 v[56:57], v164 offset:43008
  v_mfma_f32_16x16x32_bf16 v[228:231], v[128:131], v[92:95], v[228:231]
  ds_read_b64_tr_b16 v[58:59], v164 offset:45568
  v_mfma_f32_16x16x32_bf16 v[228:231], v[116:119], v[88:91], v[228:231]
  v_mfma_f32_16x16x32_bf16 v[228:231], v[104:107], v[84:87], v[228:231]
  ds_read_b128 v[24:27], v160 offset:24576
  v_mfma_f32_16x16x32_bf16 v[232:235], v[104:107], v[88:91], v[232:235]
  v_mfma_f32_16x16x32_bf16 v[232:235], v[116:119], v[92:95], v[232:235]
  ds_read_b64_tr_b16 v[60:61], v164 offset:43040
  v_mfma_f32_16x16x32_bf16 v[232:235], v[128:131], v[96:99], v[232:235]
  v_mfma_f32_16x16x32_bf16 v[236:239], v[116:119], v[96:99], v[236:239]
  ds_read_b64_tr_b16 v[62:63], v164 offset:45600
  v_mfma_f32_16x16x32_bf16 v[236:239], v[104:107], v[92:95], v[236:239]
  v_mfma_f32_16x16x32_bf16 v[240:243], v[120:123], v[68:71], v[240:243]
  ds_read_b128 v[28:31], v160 offset:28672
  v_mfma_f32_16x16x32_bf16 v[240:243], v[132:135], v[72:75], v[240:243]
  v_mfma_f32_16x16x32_bf16 v[244:247], v[132:135], v[76:79], v[244:247]
  ds_read_b64_tr_b16 v[64:65], v164 offset:43072
  v_mfma_f32_16x16x32_bf16 v[244:247], v[120:123], v[72:75], v[244:247]
  ds_read_b64_tr_b16 v[66:67], v164 offset:45632
  v_mfma_f32_16x16x32_bf16 v[244:247], v[108:111], v[68:71], v[244:247]
  v_mfma_f32_16x16x32_bf16 v[248:251], v[108:111], v[72:75], v[248:251]
  v_mfma_f32_16x16x32_bf16 v[248:251], v[120:123], v[76:79], v[248:251]
  ds_write_b32 v167, v140
  v_mfma_f32_16x16x32_bf16 v[248:251], v[132:135], v[80:83], v[248:251]
  ds_write_b32 v167, v141 offset:320
  v_mfma_f32_16x16x32_bf16 v[252:255], v[132:135], v[84:87], v[252:255]
  v_mfma_f32_16x16x32_bf16 v[252:255], v[120:123], v[80:83], v[252:255]
  v_mfma_f32_16x16x32_bf16 v[252:255], v[108:111], v[76:79], v[252:255]
  s_waitcnt lgkmcnt(0)
L_pad_lo_3:
  s_cbranch_scc1 L_warm_lo
  s_barrier
  v_mfma_f32_16x16x32_bf16 v[176:179], v[44:47], v[0:3], v[176:179]
  v_mfma_f32_16x16x32_bf16 v[176:179], v[56:59], v[4:7], v[176:179]
  ds_read_b64_tr_b16 v[100:101], v164 offset:49152
  v_mfma_f32_16x16x32_bf16 v[180:183], v[56:59], v[8:11], v[180:183]
  v_mfma_f32_16x16x32_bf16 v[180:183], v[44:47], v[4:7], v[180:183]
  ds_read_b64_tr_b16 v[102:103], v164 offset:51712
  v_mfma_f32_16x16x32_bf16 v[180:183], v[32:35], v[0:3], v[180:183]
  v_mfma_f32_16x16x32_bf16 v[184:187], v[32:35], v[4:7], v[184:187]
  ds_read_b128 v[68:71], v161 offset:0
  v_mfma_f32_16x16x32_bf16 v[184:187], v[44:47], v[8:11], v[184:187]
  v_mfma_f32_16x16x32_bf16 v[184:187], v[56:59], v[12:15], v[184:187]
  ds_read_b64_tr_b16 v[104:105], v164 offset:49184
  v_mfma_f32_16x16x32_bf16 v[188:191], v[56:59], v[16:19], v[188:191]
  v_mfma_f32_16x16x32_bf16 v[188:191], v[44:47], v[12:15], v[188:191]
  ds_read_b64_tr_b16 v[106:107], v164 offset:51744
  v_mfma_f32_16x16x32_bf16 v[188:191], v[32:35], v[8:11], v[188:191]
  v_mfma_f32_16x16x32_bf16 v[192:195], v[32:35], v[12:15], v[192:195]
  ds_read_b128 v[72:75], v161 offset:4096
  v_mfma_f32_16x16x32_bf16 v[192:195], v[44:47], v[16:19], v[192:195]
  ds_read_b64_tr_b16 v[108:109], v164 offset:49216
  v_mfma_f32_16x16x32_bf16 v[192:195], v[56:59], v[20:23], v[192:195]
  v_mfma_f32_16x16x32_bf16 v[196:199], v[56:59], v[24:27], v[196:199]
  ds_read_b64_tr_b16 v[110:111], v164 offset:51776
  v_mfma_f32_16x16x32_bf16 v[196:199], v[44:47], v[20:23], v[196:199]
  v_mfma_f32_16x16x32_bf16 v[196:199], v[32:35], v[16:19], v[196:199]
  ds_read_b128 v[76:79], v161 offset:8192
  v_mfma_f32_16x16x32_bf16 v[200:203], v[32:35], v[20:23], v[200:203]
  v_mfma_f32_16x16x32_bf16 v[200:203], v[44:47], v[24:27], v[200:203]
  ds_read_b64_tr_b16 v[112:113], v164 offset:54272
  v_mfma_f32_16x16x32_bf16 v[200:203], v[56:59], v[28:31], v[200:203]
  v_mfma_f32_16x16x32_bf16 v[204:207], v[44:47], v[28:31], v[204:207]
  ds_read_b64_tr_b16 v[114:115], v164 offset:56832
  v_mfma_f32_16x16x32_bf16 v[204:207], v[32:35], v[24:27], v[204:207]
  v_mfma_f32_16x16x32_bf16 v[208:211], v[48:51], v[0:3], v[208:211]
  ds_read_b128 v[80:83], v161 offset:12288
  v_mfma_f32_16x16x32_bf16 v[208:211], v[60:63], v[4:7], v[208:211]
  ds_read_b64_tr_b16 v[116:117], v164 offset:54304
  v_mfma_f32_16x16x32_bf16 v[212:215], v[60:63], v[8:11], v[212:215]
  v_mfma_f32_16x16x32_bf16 v[212:215], v[48:51], v[4:7], v[212:215]
  ds_read_b64_tr_b16 v[118:119], v164 offset:56864
  v_mfma_f32_16x16x32_bf16 v[212:215], v[36:39], v[0:3], v[212:215]
  v_mfma_f32_16x16x32_bf16 v[216:219], v[36:39], v[4:7], v[216:219]
  ds_read_b128 v[84:87], v161 offset:16384
  v_mfma_f32_16x16x32_bf16 v[216:219], v[48:51], v[8:11], v[216:219]
  v_mfma_f32_16x16x32_bf16 v[216:219], v[60:63], v[12:15], v[216:219]
  ds_read_b64_tr_b16 v[120:121], v164 offset:54336
  v_mfma_f32_16x16x32_bf16 v[220:223], v[60:63], v[16:19], v[220:223]
  v_mfma_f32_16x16x32_bf16 v[220:223], v[48:51], v[12:15], v[220:223]
  ds_read_b64_tr_b16 v[122:123], v164 offset:56896
  v_mfma_f32_16x16x32_bf16 v[220:223], v[36:39], v[8:11], v[220:223]
  v_mfma_f32_16x16x32_bf16 v[224:227], v[36:39], v[12:15], v[224:227]
  ds_read_b128 v[88:91], v161 offset:20480
  v_mfma_f32_16x16x32_bf16 v[224:227], v[48:51], v[16:19], v[224:227]
  v_mfma_f32_16x16x32_bf16 v[224:227], v[60:63], v[20:23], v[224:227]
  ds_read_b64_tr_b16 v[124:125], v164 offset:59392
  v_mfma_f32_16x16x32_bf16 v[228:231], v[60:63], v[24:27], v[228:231]
  ds_read_b64_tr_b16 v[126:127], v164 offset:61952
  v_mfma_f32_16x16x32_bf16 v[228:231], v[48:51], v[20:23], v[228:231]
  v_mfma_f32_16x16x32_bf16 v[228:231], v[36:39], v[16:19], v[228:231]
  ds_read_b128 v[92:95], v161 offset:24576
  v_mfma_f32_16x16x32_bf16 v[232:235], v[36:39], v[20:23], v[232:235]
  v_mfma_f32_16x16x32_bf16 v[232:235], v[48:51], v[24:27], v[232:235]
  ds_read_b64_tr_b16 v[128:129], v164 offset:59424
  v_mfma_f32_16x16x32_bf16 v[232:235], v[60:63], v[28:31], v[232:235]
  v_mfma_f32_16x16x32_bf16 v[236:239], v[48:51], v[28:31], v[236:239]
  ds_read_b64_tr_b16 v[130:131], v164 offset:61984
  v_mfma_f32_16x16x32_bf16 v[236:239], v[36:39], v[24:27], v[236:239]
  v_mfma_f32_16x16x32_bf16 v[240:243], v[52:55], v[0:3], v[240:243]
  ds_read_b128 v[96:99], v161 offset:28672
  v_mfma_f32_16x16x32_bf16 v[240:243], v[64:67], v[4:7], v[240:243]
  v_mfma_f32_16x16x32_bf16 v[244:247], v[64:67], v[8:11], v[244:247]
  ds_read_b64_tr_b16 v[132:133], v164 offset:59456
  v_mfma_f32_16x16x32_bf16 v[244:247], v[52:55], v[4:7], v[244:247]
  ds_read_b64_tr_b16 v[134:135], v164 offset:62016
  v_mfma_f32_16x16x32_bf16 v[244:247], v[40:43], v[0:3], v[244:247]
  v_mfma_f32_16x16x32_bf16 v[248:251], v[40:43], v[4:7], v[248:251]
  v_mfma_f32_16x16x32_bf16 v[248:251], v[52:55], v[8:11], v[248:251]
  v_mfma_f32_16x16x32_bf16 v[248:251], v[64:67], v[12:15], v[248:251]
  v_mfma_f32_16x16x32_bf16 v[252:255], v[64:67], v[16:19], v[252:255]
  v_mfma_f32_16x16x32_bf16 v[252:255], v[52:55], v[12:15], v[252:255]
  v_mfma_f32_16x16x32_bf16 v[252:255], v[40:43], v[8:11], v[252:255]
  s_waitcnt lgkmcnt(0)
  s_barrier
  v_mfma_f32_16x16x32_bf16 v[176:179], v[112:115], v[68:71], v[176:179]
  v_mfma_f32_16x16x32_bf16 v[176:179], v[124:127], v[72:75], v[176:179]
  v_mfma_f32_16x16x32_bf16 v[180:183], v[124:127], v[76:79], v[180:183]
  v_mfma_f32_16x16x32_bf16 v[180:183], v[112:115], v[72:75], v[180:183]
  ds_read_b128 v[52:55], v166 offset:0
  v_mfma_f32_16x16x32_bf16 v[180:183], v[100:103], v[68:71], v[180:183]
  v_mfma_f32_16x16x32_bf16 v[184:187], v[100:103], v[72:75], v[184:187]
  v_mfma_f32_16x16x32_bf16 v[184:187], v[112:115], v[76:79], v[184:187]
  v_mfma_f32_16x16x32_bf16 v[184:187], v[124:127], v[80:83], v[184:187]
  ds_read_b128 v[136:139], v166 offset:320
  v_mfma_f32_16x16x32_bf16 v[188:191], v[124:127], v[84:87], v[188:191]
  v_mfma_f32_16x16x32_bf16 v[188:191], v[112:115], v[80:83], v[188:191]
  v_mfma_f32_16x16x32_bf16 v[188:191], v[100:103], v[76:79], v[188:191]
  v_mfma_f32_16x16x32_bf16 v[192:195], v[100:103], v[80:83], v[192:195]
  ds_read_b128 v[56:59], v166 offset:64
  v_mfma_f32_16x16x32_bf16 v[192:195], v[112:115], v[84:87], v[192:195]
  v_mfma_f32_16x16x32_bf16 v[192:195], v[124:127], v[88:91], v[192:195]
  v_mfma_f32_16x16x32_bf16 v[196:199], v[124:127], v[92:95], v[196:199]
  ds_read_b128 v[140:143], v166 offset:384
  v_mfma_f32_16x16x32_bf16 v[196:199], v[112:115], v[88:91], v[196:199]
  v_mfma_f32_16x16x32_bf16 v[196:199], v[100:103], v[84:87], v[196:199]
  v_mfma_f32_16x16x32_bf16 v[200:203], v[100:103], v[88:91], v[200:203]
  v_mfma_f32_16x16x32_bf16 v[200:203], v[112:115], v[92:95], v[200:203]
  ds_read_b128 v[60:63], v166 offset:128
  v_mfma_f32_16x16x32_bf16 v[200:203], v[124:127], v[96:99], v[200:203]
  v_mfma_f32_16x16x32_bf16 v[204:207], v[112:115], v[96:99], v[204:207]
  v_mfma_f32_16x16x32_bf16 v[204:207], v[100:103], v[92:95], v[204:207]
  v_mfma_f32_16x16x32_bf16 v[208:211], v[116:119], v[68:71], v[208:211]
  ds_read_b128 v[144:147], v166 offset:448
  v_mfma_f32_16x16x32_bf16 v[208:211], v[128:131], v[72:75], v[208:211]
  v_mfma_f32_16x16x32_bf16 v[212:215], v[128:131], v[76:79], v[212:215]
  v_mfma_f32_16x16x32_bf16 v[212:215], v[116:119], v[72:75], v[212:215]
  v_mfma_f32_16x16x32_bf16 v[212:215], v[104:107], v[68:71], v[212:215]
  v_mov_b32 v64, 0xbfb8aa3b
  v_mfma_f32_16x16x32_bf16 v[216:219], v[104:107], v[72:75], v[216:219]
  v_mfma_f32_16x16x32_bf16 v[216:219], v[116:119], v[76:79], v[216:219]
  v_mfma_f32_16x16x32_bf16 v[216:219], v[128:131], v[80:83], v[216:219]
  v_mov_b32 v65, 0xbfb8aa3b
  v_mfma_f32_16x16x32_bf16 v[220:223], v[128:131], v[84:87], v[220:223]
  v_mfma_f32_16x16x32_bf16 v[220:223], v[116:119], v[80:83], v[220:223]
  v_mfma_f32_16x16x32_bf16 v[220:223], v[104:107], v[76:79], v[220:223]
  v_mfma_f32_16x16x32_bf16 v[224:227], v[104:107], v[80:83], v[224:227]
  v_mfma_f32_16x16x32_bf16 v[224:227], v[116:119], v[84:87], v[224:227]
  v_mfma_f32_16x16x32_bf16 v[224:227], v[128:131], v[88:91], v[224:227]
  v_mfma_f32_16x16x32_bf16 v[228:231], v[128:131], v[92:95], v[228:231]
  v_mfma_f32_16x16x32_bf16 v[228:231], v[116:119], v[88:91], v[228:231]
  v_mfma_f32_16x16x32_bf16 v[228:231], v[104:107], v[84:87], v[228:231]
  v_mfma_f32_16x16x32_bf16 v[232:235], v[104:107], v[88:91], v[232:235]
  v_mfma_f32_16x16x32_bf16 v[232:235], v[116:119], v[92:95], v[232:235]
  v_mfma_f32_16x16x32_bf16 v[232:235], v[128:131], v[96:99], v[232:235]
  v_mfma_f32_16x16x32_bf16 v[236:239], v[116:119], v[96:99], v[236:239]
  v_mfma_f32_16x16x32_bf16 v[236:239], v[104:107], v[92:95], v[236:239]
  v_mfma_f32_16x16x32_bf16 v[240:243], v[120:123], v[68:71], v[240:243]
  v_mfma_f32_16x16x32_bf16 v[240:243], v[132:135], v[72:75], v[240:243]
  v_mfma_f32_16x16x32_bf16 v[244:247], v[132:135], v[76:79], v[244:247]
  v_mfma_f32_16x16x32_bf16 v[244:247], v[120:123], v[72:75], v[244:247]
  v_mfma_f32_16x16x32_bf16 v[244:247], v[108:111], v[68:71], v[244:247]
  v_mfma_f32_16x16x32_bf16 v[248:251], v[108:111], v[72:75], v[248:251]
  v_mfma_f32_16x16x32_bf16 v[248:251], v[120:123], v[76:79], v[248:251]
  v_mfma_f32_16x16x32_bf16 v[248:251], v[132:135], v[80:83], v[248:251]
  v_mfma_f32_16x16x32_bf16 v[252:255], v[132:135], v[84:87], v[252:255]
  v_mfma_f32_16x16x32_bf16 v[252:255], v[120:123], v[80:83], v[252:255]
  v_mfma_f32_16x16x32_bf16 v[252:255], v[108:111], v[76:79], v[252:255]
  s_waitcnt lgkmcnt(0)
  s_nop 0
  v_pk_fma_f32 v[0:1], v[176:177], v[52:53], v[136:137]
  v_pk_fma_f32 v[2:3], v[178:179], v[54:55], v[138:139]
  v_pk_fma_f32 v[4:5], v[208:209], v[56:57], v[140:141]
  v_pk_fma_f32 v[6:7], v[210:211], v[58:59], v[142:143]
  v_pk_fma_f32 v[8:9], v[240:241], v[60:61], v[144:145]
  v_pk_fma_f32 v[10:11], v[242:243], v[62:63], v[146:147]
  v_pk_fma_f32 v[12:13], v[192:193], v[52:53], v[136:137]
  v_pk_fma_f32 v[14:15], v[194:195], v[54:55], v[138:139]
  v_pk_fma_f32 v[16:17], v[224:225], v[56:57], v[140:141]
  v_pk_fma_f32 v[18:19], v[226:227], v[58:59], v[142:143]
  v_exp_f32 v20, v0
  v_exp_f32 v21, v1
  v_exp_f32 v22, v2
  v_exp_f32 v23, v3
  v_exp_f32 v24, v4
  v_exp_f32 v25, v5
  v_exp_f32 v26, v6
  v_exp_f32 v27, v7
  v_exp_f32 v28, v8
  v_exp_f32 v29, v9
  v_exp_f32 v30, v10
  v_exp_f32 v31, v11
  v_exp_f32 v32, v12
  v_exp_f32 v33, v13
  v_exp_f32 v34, v14
  v_exp_f32 v35, v15
  v_exp_f32 v36, v16
  v_exp_f32 v37, v17
  v_exp_f32 v38, v18
  v_exp_f32 v39, v19
  v_pk_fma_f32 v[20:21], v[20:21], v[64:65], v[64:65]
  v_pk_fma_f32 v[22:23], v[22:23], v[64:65], v[64:65]
  v_pk_fma_f32 v[24:25], v[24:25], v[64:65], v[64:65]
  v_pk_fma_f32 v[26:27], v[26:27], v[64:65], v[64:65]
  v_pk_fma_f32 v[28:29], v[28:29], v[64:65], v[64:65]
  v_pk_fma_f32 v[30:31], v[30:31], v[64:65], v[64:65]
  v_pk_fma_f32 v[32:33], v[32:33], v[64:65], v[64:65]
  v_pk_fma_f32 v[34:35], v[34:35], v[64:65], v[64:65]
  v_pk_fma_f32 v[36:37], v[36:37], v[64:65], v[64:65]
  v_pk_fma_f32 v[38:39], v[38:39], v[64:65], v[64:65]
  v_rcp_f32 v20, v20
  v_rcp_f32 v21, v21
  v_rcp_f32 v22, v22
  v_rcp_f32 v23, v23
  v_rcp_f32 v24, v24
  v_rcp_f32 v25, v25
  v_rcp_f32 v26, v26
  v_rcp_f32 v27, v27
  v_rcp_f32 v28, v28
  v_rcp_f32 v29, v29
  v_rcp_f32 v30, v30
  v_rcp_f32 v31, v31
  v_rcp_f32 v32, v32
  v_rcp_f32 v33, v33
  v_rcp_f32 v34, v34
  v_rcp_f32 v35, v35
  v_rcp_f32 v36, v36
  v_rcp_f32 v37, v37
  v_rcp_f32 v38, v38
  v_rcp_f32 v39, v39
  v_pk_mul_f32 v[0:1], v[0:1], v[20:21]
  v_pk_mul_f32 v[2:3], v[2:3], v[22:23]
  v_pk_mul_f32 v[4:5], v[4:5], v[24:25]
  v_pk_mul_f32 v[6:7], v[6:7], v[26:27]
  v_pk_mul_f32 v[8:9], v[8:9], v[28:29]
  v_pk_mul_f32 v[10:11], v[10:11], v[30:31]
  v_pk_mul_f32 v[12:13], v[12:13], v[32:33]
  v_pk_mul_f32 v[14:15], v[14:15], v[34:35]
  v_pk_mul_f32 v[16:17], v[16:17], v[36:37]
  v_pk_mul_f32 v[18:19], v[18:19], v[38:39]
  v_cvt_pk_bf16_f32 v40, v0, v1
  v_cvt_pk_bf16_f32 v41, v2, v3
  ds_write_b64 v165, v[40:41] offset:0
  v_cvt_pk_bf16_f32 v42, v4, v5
  v_cvt_pk_bf16_f32 v43, v6, v7
  ds_write_b64 v165, v[42:43] offset:32
  v_cvt_pk_bf16_f32 v44, v8, v9
  v_cvt_pk_bf16_f32 v45, v10, v11
  ds_write_b64 v165, v[44:45] offset:64
  v_cvt_pk_bf16_f32 v46, v12, v13
  v_cvt_pk_bf16_f32 v47, v14, v15
  ds_write_b64 v165, v[46:47] offset:22528
  v_cvt_pk_bf16_f32 v48, v16, v17
  v_cvt_pk_bf16_f32 v49, v18, v19
  ds_write_b64 v165, v[48:49] offset:22560
  v_pk_fma_f32 v[0:1], v[180:181], v[52:53], v[136:137]
  v_pk_fma_f32 v[2:3], v[182:183], v[54:55], v[138:139]
  v_pk_fma_f32 v[4:5], v[212:213], v[56:57], v[140:141]
  v_pk_fma_f32 v[6:7], v[214:215], v[58:59], v[142:143]
  v_pk_fma_f32 v[8:9], v[244:245], v[60:61], v[144:145]
  v_pk_fma_f32 v[10:11], v[246:247], v[62:63], v[146:147]
  v_pk_fma_f32 v[12:13], v[196:197], v[52:53], v[136:137]
  v_pk_fma_f32 v[14:15], v[198:199], v[54:55], v[138:139]
  v_pk_fma_f32 v[16:17], v[228:229], v[56:57], v[140:141]
  v_pk_fma_f32 v[18:19], v[230:231], v[58:59], v[142:143]
  v_exp_f32 v20, v0
  v_exp_f32 v21, v1
  v_exp_f32 v22, v2
  v_exp_f32 v23, v3
  v_exp_f32 v24, v4
  v_exp_f32 v25, v5
  v_exp_f32 v26, v6
  v_exp_f32 v27, v7
  v_exp_f32 v28, v8
  v_exp_f32 v29, v9
  v_exp_f32 v30, v10
  v_exp_f32 v31, v11
  v_exp_f32 v32, v12
  v_exp_f32 v33, v13
  v_exp_f32 v34, v14
  v_exp_f32 v35, v15
  v_exp_f32 v36, v16
  v_exp_f32 v37, v17
  v_exp_f32 v38, v18
  v_exp_f32 v39, v19
  s_waitcnt lgkmcnt(0)
  s_barrier
  v_pk_fma_f32 v[20:21], v[20:21], v[64:65], v[64:65]
  v_pk_fma_f32 v[22:23], v[22:23], v[64:65], v[64:65]
  v_pk_fma_f32 v[24:25], v[24:25], v[64:65], v[64:65]
  v_pk_fma_f32 v[26:27], v[26:27], v[64:65], v[64:65]
  v_pk_fma_f32 v[28:29], v[28:29], v[64:65], v[64:65]
  v_pk_fma_f32 v[30:31], v[30:31], v[64:65], v[64:65]
  v_pk_fma_f32 v[32:33], v[32:33], v[64:65], v[64:65]
  v_pk_fma_f32 v[34:35], v[34:35], v[64:65], v[64:65]
  v_pk_fma_f32 v[36:37], v[36:37], v[64:65], v[64:65]
  v_pk_fma_f32 v[38:39], v[38:39], v[64:65], v[64:65]
  v_rcp_f32 v20, v20
  v_rcp_f32 v21, v21
  v_rcp_f32 v22, v22
  v_rcp_f32 v23, v23
  v_rcp_f32 v24, v24
  v_rcp_f32 v25, v25
  v_rcp_f32 v26, v26
  v_rcp_f32 v27, v27
  v_rcp_f32 v28, v28
  v_rcp_f32 v29, v29
  v_rcp_f32 v30, v30
  v_rcp_f32 v31, v31
  v_rcp_f32 v32, v32
  v_rcp_f32 v33, v33
  v_rcp_f32 v34, v34
  v_rcp_f32 v35, v35
  v_rcp_f32 v36, v36
  v_rcp_f32 v37, v37
  v_rcp_f32 v38, v38
  v_rcp_f32 v39, v39
  v_pk_mul_f32 v[0:1], v[0:1], v[20:21]
  v_pk_mul_f32 v[2:3], v[2:3], v[22:23]
  v_pk_mul_f32 v[4:5], v[4:5], v[24:25]
  v_pk_mul_f32 v[6:7], v[6:7], v[26:27]
  v_pk_mul_f32 v[8:9], v[8:9], v[28:29]
  v_pk_mul_f32 v[10:11], v[10:11], v[30:31]
  v_pk_mul_f32 v[12:13], v[12:13], v[32:33]
  v_pk_mul_f32 v[14:15], v[14:15], v[34:35]
  v_pk_mul_f32 v[16:17], v[16:17], v[36:37]
  v_pk_mul_f32 v[18:19], v[18:19], v[38:39]
  v_cvt_pk_bf16_f32 v40, v0, v1
  v_cvt_pk_bf16_f32 v41, v2, v3
  ds_write_b64 v165, v[40:41] offset:5632
  v_cvt_pk_bf16_f32 v42, v4, v5
  v_cvt_pk_bf16_f32 v43, v6, v7
  ds_write_b64 v165, v[42:43] offset:5664
  v_cvt_pk_bf16_f32 v44, v8, v9
  v_cvt_pk_bf16_f32 v45, v10, v11
  ds_write_b64 v165, v[44:45] offset:5696
  v_cvt_pk_bf16_f32 v46, v12, v13
  v_cvt_pk_bf16_f32 v47, v14, v15
  ds_write_b64 v165, v[46:47] offset:28160
  v_cvt_pk_bf16_f32 v48, v16, v17
  v_cvt_pk_bf16_f32 v49, v18, v19
  ds_write_b64 v165, v[48:49] offset:28192
  v_pk_fma_f32 v[0:1], v[184:185], v[52:53], v[136:137]
  v_pk_fma_f32 v[2:3], v[186:187], v[54:55], v[138:139]
  v_pk_fma_f32 v[4:5], v[216:217], v[56:57], v[140:141]
  v_pk_fma_f32 v[6:7], v[218:219], v[58:59], v[142:143]
  v_pk_fma_f32 v[8:9], v[248:249], v[60:61], v[144:145]
  v_pk_fma_f32 v[10:11], v[250:251], v[62:63], v[146:147]
  v_pk_fma_f32 v[12:13], v[200:201], v[52:53], v[136:137]
  v_pk_fma_f32 v[14:15], v[202:203], v[54:55], v[138:139]
  v_pk_fma_f32 v[16:17], v[232:233], v[56:57], v[140:141]
  v_pk_fma_f32 v[18:19], v[234:235], v[58:59], v[142:143]
  v_exp_f32 v20, v0
  v_exp_f32 v21, v1
  v_exp_f32 v22, v2
  v_exp_f32 v23, v3
  v_exp_f32 v24, v4
  v_exp_f32 v25, v5
  v_exp_f32 v26, v6
  v_exp_f32 v27, v7
  v_exp_f32 v28, v8
  v_exp_f32 v29, v9
  v_exp_f32 v30, v10
  v_exp_f32 v31, v11
  v_exp_f32 v32, v12
  v_exp_f32 v33, v13
  v_exp_f32 v34, v14
  v_exp_f32 v35, v15
  v_exp_f32 v36, v16
  v_exp_f32 v37, v17
  v_exp_f32 v38, v18
  v_exp_f32 v39, v19
  s_waitcnt lgkmcnt(0)
  s_barrier
  v_pk_fma_f32 v[20:21], v[20:21], v[64:65], v[64:65]
  v_pk_fma_f32 v[22:23], v[22:23], v[64:65], v[64:65]
  v_pk_fma_f32 v[24:25], v[24:25], v[64:65], v[64:65]
  v_pk_fma_f32 v[26:27], v[26:27], v[64:65], v[64:65]
  v_pk_fma_f32 v[28:29], v[28:29], v[64:65], v[64:65]
  v_pk_fma_f32 v[30:31], v[30:31], v[64:65], v[64:65]
  v_pk_fma_f32 v[32:33], v[32:33], v[64:65], v[64:65]
  v_pk_fma_f32 v[34:35], v[34:35], v[64:65], v[64:65]
  v_pk_fma_f32 v[36:37], v[36:37], v[64:65], v[64:65]
  v_pk_fma_f32 v[38:39], v[38:39], v[64:65], v[64:65]
  v_rcp_f32 v20, v20
  v_rcp_f32 v21, v21
  v_rcp_f32 v22, v22
  v_rcp_f32 v23, v23
  v_rcp_f32 v24, v24
  v_rcp_f32 v25, v25
  v_rcp_f32 v26, v26
  v_rcp_f32 v27, v27
  v_rcp_f32 v28, v28
  v_rcp_f32 v29, v29
  v_rcp_f32 v30, v30
  v_rcp_f32 v31, v31
  v_rcp_f32 v32, v32
  v_rcp_f32 v33, v33
  v_rcp_f32 v34, v34
  v_rcp_f32 v35, v35
  v_rcp_f32 v36, v36
  v_rcp_f32 v37, v37
  v_rcp_f32 v38, v38
  v_rcp_f32 v39, v39
  v_pk_mul_f32 v[0:1], v[0:1], v[20:21]
  v_pk_mul_f32 v[2:3], v[2:3], v[22:23]
  v_pk_mul_f32 v[4:5], v[4:5], v[24:25]
  v_pk_mul_f32 v[6:7], v[6:7], v[26:27]
  v_pk_mul_f32 v[8:9], v[8:9], v[28:29]
  v_pk_mul_f32 v[10:11], v[10:11], v[30:31]
  v_pk_mul_f32 v[12:13], v[12:13], v[32:33]
  v_pk_mul_f32 v[14:15], v[14:15], v[34:35]
  v_pk_mul_f32 v[16:17], v[16:17], v[36:37]
  v_pk_mul_f32 v[18:19], v[18:19], v[38:39]
  v_cvt_pk_bf16_f32 v40, v0, v1
  v_cvt_pk_bf16_f32 v41, v2, v3
  ds_write_b64 v165, v[40:41] offset:11264
  v_cvt_pk_bf16_f32 v42, v4, v5
  v_cvt_pk_bf16_f32 v43, v6, v7
  ds_write_b64 v165, v[42:43] offset:11296
  v_cvt_pk_bf16_f32 v44, v8, v9
  v_cvt_pk_bf16_f32 v45, v10, v11
  ds_write_b64 v165, v[44:45] offset:11328
  v_cvt_pk_bf16_f32 v46, v12, v13
  v_cvt_pk_bf16_f32 v47, v14, v15
  ds_write_b64 v165, v[46:47] offset:33792
  v_cvt_pk_bf16_f32 v48, v16, v17
  v_cvt_pk_bf16_f32 v49, v18, v19
  ds_write_b64 v165, v[48:49] offset:33824
  v_pk_fma_f32 v[0:1], v[188:189], v[52:53], v[136:137]
  v_pk_fma_f32 v[2:3], v[190:191], v[54:55], v[138:139]
  v_pk_fma_f32 v[4:5], v[220:221], v[56:57], v[140:141]
  v_pk_fma_f32 v[6:7], v[222:223], v[58:59], v[142:143]
  v_pk_fma_f32 v[8:9], v[252:253], v[60:61], v[144:145]
  v_pk_fma_f32 v[10:11], v[254:255], v[62:63], v[146:147]
  v_pk_fma_f32 v[12:13], v[204:205], v[52:53], v[136:137]
  v_pk_fma_f32 v[14:15], v[206:207], v[54:55], v[138:139]
  v_pk_fma_f32 v[16:17], v[236:237], v[56:57], v[140:141]
  v_pk_fma_f32 v[18:19], v[238:239], v[58:59], v[142:143]
  v_exp_f32 v20, v0
  v_exp_f32 v21, v1
  v_exp_f32 v22, v2
  v_exp_f32 v23, v3
  v_exp_f32 v24, v4
  v_exp_f32 v25, v5
  v_exp_f32 v26, v6
  v_exp_f32 v27, v7
  v_exp_f32 v28, v8
  v_exp_f32 v29, v9
  v_exp_f32 v30, v10
  v_exp_f32 v31, v11
  v_exp_f32 v32, v12
  v_exp_f32 v33, v13
  v_exp_f32 v34, v14
  v_exp_f32 v35, v15
  v_exp_f32 v36, v16
  v_exp_f32 v37, v17
  v_exp_f32 v38, v18
  v_exp_f32 v39, v19
  s_waitcnt lgkmcnt(0)
  s_barrier
  v_pk_fma_f32 v[20:21], v[20:21], v[64:65], v[64:65]
  v_pk_fma_f32 v[22:23], v[22:23], v[64:65], v[64:65]
  v_pk_fma_f32 v[24:25], v[24:25], v[64:65], v[64:65]
  v_pk_fma_f32 v[26:27], v[26:27], v[64:65], v[64:65]
  v_pk_fma_f32 v[28:29], v[28:29], v[64:65], v[64:65]
  v_pk_fma_f32 v[30:31], v[30:31], v[64:65], v[64:65]
  v_pk_fma_f32 v[32:33], v[32:33], v[64:65], v[64:65]
  v_pk_fma_f32 v[34:35], v[34:35], v[64:65], v[64:65]
  v_pk_fma_f32 v[36:37], v[36:37], v[64:65], v[64:65]
  v_pk_fma_f32 v[38:39], v[38:39], v[64:65], v[64:65]
  v_rcp_f32 v20, v20
  v_rcp_f32 v21, v21
  v_rcp_f32 v22, v22
  v_rcp_f32 v23, v23
  v_rcp_f32 v24, v24
  v_rcp_f32 v25, v25
  v_rcp_f32 v26, v26
  v_rcp_f32 v27, v27
  v_rcp_f32 v28, v28
  v_rcp_f32 v29, v29
  v_rcp_f32 v30, v30
  v_rcp_f32 v31, v31
  v_rcp_f32 v32, v32
  v_rcp_f32 v33, v33
  v_rcp_f32 v34, v34
  v_rcp_f32 v35, v35
  v_rcp_f32 v36, v36
  v_rcp_f32 v37, v37
  v_rcp_f32 v38, v38
  v_rcp_f32 v39, v39
  v_pk_mul_f32 v[0:1], v[0:1], v[20:21]
  v_pk_mul_f32 v[2:3], v[2:3], v[22:23]
  v_pk_mul_f32 v[4:5], v[4:5], v[24:25]
  v_pk_mul_f32 v[6:7], v[6:7], v[26:27]
  v_pk_mul_f32 v[8:9], v[8:9], v[28:29]
  v_pk_mul_f32 v[10:11], v[10:11], v[30:31]
  v_pk_mul_f32 v[12:13], v[12:13], v[32:33]
  v_pk_mul_f32 v[14:15], v[14:15], v[34:35]
  v_pk_mul_f32 v[16:17], v[16:17], v[36:37]
  v_pk_mul_f32 v[18:19], v[18:19], v[38:39]
  v_cvt_pk_bf16_f32 v40, v0, v1
  v_cvt_pk_bf16_f32 v41, v2, v3
  ds_write_b64 v165, v[40:41] offset:16896
  v_cvt_pk_bf16_f32 v42, v4, v5
  v_cvt_pk_bf16_f32 v43, v6, v7
  ds_write_b64 v165, v[42:43] offset:16928
  v_cvt_pk_bf16_f32 v44, v8, v9
  v_cvt_pk_bf16_f32 v45, v10, v11
  ds_write_b64 v165, v[44:45] offset:16960
  v_cvt_pk_bf16_f32 v46, v12, v13
  v_cvt_pk_bf16_f32 v47, v14, v15
  ds_write_b64 v165, v[46:47] offset:39424
  v_cvt_pk_bf16_f32 v48, v16, v17
  v_cvt_pk_bf16_f32 v49, v18, v19
  ds_write_b64 v165, v[48:49] offset:39456
  s_waitcnt lgkmcnt(0)
  s_barrier
L_end_lo:
  s_endpgm
.p2align 12
L_cons_hi:
  s_lshr_b32 s28, s23, 1
  v_and_b32 v1, 15, v0
  v_lshrrev_b32 v2, 4, v0
  v_lshrrev_b32 v3, 1, v1
  v_xor_b32 v3, v3, v2
  v_lshlrev_b32 v3, 4, v3
  v_lshl_add_u32 v3, v1, 7, v3
  s_lshl_b32 s29, s28, 11
  v_add_u32 v160, s29, v3
  v_xor_b32 v161, 64, v160
  v_add_u32 v162, 0x10000, v160
  v_add_u32 v163, 0x10000, v161
  v_lshrrev_b32 v3, 2, v1
  v_lshl_add_u32 v3, v2, 2, v3
  v_mul_u32_u24 v3, 160, v3
  v_and_b32 v4, 3, v1
  v_lshl_add_u32 v3, v4, 3, v3
  v_add_u32 v164, 98304, v3
  s_lshl_b32 s29, s28, 4
  v_add_u32 v3, s29, v1
  v_mul_u32_u24 v3, 176, v3
  v_lshl_add_u32 v165, v2, 3, v3
  v_lshlrev_b32 v3, 4, v2
  v_add_u32 v166, 49152, v3
  v_min_u32 v3, 19, v0
  s_mul_i32 s29, s23, 20
  v_add_u32 v3, s29, v3
  v_lshlrev_b32 v4, 2, v3
  v_add_u32 v167, 49152, v4
  s_cmp_eq_u32 s28, 0
  s_cbranch_scc1 L_pad_hi_1
  s_cmp_eq_u32 s28, 1
  s_branch L_pad_hi_3
L_warm_hi:
  s_cmp_lg_u32 s2, s2
  s_barrier
  ds_read_b64_tr_b16 v[32:33], v164 offset:96
  ds_read_b64_tr_b16 v[34:35], v164 offset:2656
  ds_read_b128 v[0:3], v160 offset:0
  ds_read_b64_tr_b16 v[36:37], v164 offset:128
  ds_read_b64_tr_b16 v[38:39], v164 offset:2688
  ds_read_b128 v[4:7], v160 offset:4096
  ds_read_b64_tr_b16 v[40:41], v164 offset:64
  ds_read_b64_tr_b16 v[42:43], v164 offset:2624
  ds_read_b128 v[8:11], v160 offset:8192
  ds_read_b64_tr_b16 v[44:45], v164 offset:5216
  ds_read_b64_tr_b16 v[46:47], v164 offset:7776
  ds_read_b128 v[12:15], v160 offset:12288
  ds_read_b64_tr_b16 v[48:49], v164 offset:5248
  ds_read_b64_tr_b16 v[50:51], v164 offset:7808
  ds_read_b128 v[16:19], v160 offset:16384
  ds_read_b64_tr_b16 v[52:53], v164 offset:5184
  ds_read_b64_tr_b16 v[54:55], v164 offset:7744
  ds_read_b128 v[20:23], v160 offset:20480
  ds_read_b64_tr_b16 v[56:57], v164 offset:10336
  ds_read_b64_tr_b16 v[58:59], v164 offset:12896
  ds_read_b128 v[24:27], v160 offset:24576
  ds_read_b64_tr_b16 v[60:61], v164 offset:10368
  ds_read_b64_tr_b16 v[62:63], v164 offset:12928
  ds_read_b128 v[28:31], v160 offset:28672
  ds_read_b64_tr_b16 v[64:65], v164 offset:10304
  ds_read_b64_tr_b16 v[66:67], v164 offset:12864
  s_waitcnt lgkmcnt(0)
  v_mfma_f32_16x16x32_bf16 v[176:179], v[44:47], v[0:3], 0
  v_mfma_f32_16x16x32_bf16 v[176:179], v[56:59], v[4:7], v[176:179]
  v_mfma_f32_16x16x32_bf16 v[180:183], v[56:59], v[8:11], 0
  v_mfma_f32_16x16x32_bf16 v[180:183], v[44:47], v[4:7], v[180:183]
  v_mfma_f32_16x16x32_bf16 v[180:183], v[32:35], v[0:3], v[180:183]
  v_mfma_f32_16x16x32_bf16 v[184:187], v[32:35], v[4:7], 0
  v_mfma_f32_16x16x32_bf16 v[184:187], v[44:47], v[8:11], v[184:187]
  v_mfma_f32_16x16x32_bf16 v[184:187], v[56:59], v[12:15], v[184:187]
  v_mfma_f32_16x16x32_bf16 v[188:191], v[56:59], v[16:19], 0
  v_mfma_f32_16x16x32_bf16 v[188:191], v[44:47], v[12:15], v[188:191]
  v_mfma_f32_16x16x32_bf16 v[188:191], v[32:35], v[8:11], v[188:191]
  v_mfma_f32_16x16x32_bf16 v[192:195], v[32:35], v[12:15], 0
  v_mfma_f32_16x16x32_bf16 v[192:195], v[44:47], v[16:19], v[192:195]
  v_mfma_f32_16x16x32_bf16 v[192:195], v[56:59], v[20:23], v[192:195]
  v_mfma_f32_16x16x32_bf16 v[196:199], v[56:59], v[24:27], 0
  v_mfma_f32_16x16x32_bf16 v[196:199], v[44:47], v[20:23], v[196:199]
  v_mfma_f32_16x16x32_bf16 v[196:199], v[32:35], v[16:19], v[196:199]
  v_mfma_f32_16x16x32_bf16 v[200:203], v[32:35], v[20:23], 0
  v_mfma_f32_16x16x32_bf16 v[200:203], v[44:47], v[24:27], v[200:203]
  v_mfma_f32_16x16x32_bf16 v[200:203], v[56:59], v[28:31], v[200:203]
  s_barrier
  v_mfma_f32_16x16x32_bf16 v[204:207], v[44:47], v[28:31], 0
  v_mfma_f32_16x16x32_bf16 v[204:207], v[32:35], v[24:27], v[204:207]
  ds_read_b64_tr_b16 v[100:101], v164 offset:16480
  v_mfma_f32_16x16x32_bf16 v[208:211], v[48:51], v[0:3], 0
  ds_read_b64_tr_b16 v[102:103], v164 offset:19040
  v_mfma_f32_16x16x32_bf16 v[208:211], v[60:63], v[4:7], v[208:211]
  ds_read_b128 v[68:71], v161 offset:0
  v_mfma_f32_16x16x32_bf16 v[212:215], v[60:63], v[8:11], 0
  ds_read_b64_tr_b16 v[104:105], v164 offset:16512
  v_mfma_f32_16x16x32_bf16 v[212:215], v[48:51], v[4:7], v[212:215]
  ds_read_b64_tr_b16 v[106:107], v164 offset:19072
  v_mfma_f32_16x16x32_bf16 v[212:215], v[36:39], v[0:3], v[212:215]
  ds_read_b128 v[72:75], v161 offset:4096
  v_mfma_f32_16x16x32_bf16 v[216:219], v[36:39], v[4:7], 0
  v_mfma_f32_16x16x32_bf16 v[216:219], v[48:51], v[8:11], v[216:219]
  ds_read_b64_tr_b16 v[108:109], v164 offset:16448
  v_mfma_f32_16x16x32_bf16 v[216:219], v[60:63], v[12:15], v[216:219]
  ds_read_b64_tr_b16 v[110:111], v164 offset:19008
  v_mfma_f32_16x16x32_bf16 v[220:223], v[60:63], v[16:19], 0
  ds_read_b128 v[76:79], v161 offset:8192
  v_mfma_f32_16x16x32_bf16 v[220:223], v[48:51], v[12:15], v[220:223]
  ds_read_b64_tr_b16 v[112:113], v164 offset:21600
  v_mfma_f32_16x16x32_bf16 v[220:223], v[36:39], v[8:11], v[220:223]
  ds_read_b64_tr_b16 v[114:115], v164 offset:24160
  v_mfma_f32_16x16x32_bf16 v[224:227], v[36:39], v[12:15], 0
  ds_read_b128 v[80:83], v161 offset:12288
  v_mfma_f32_16x16x32_bf16 v[224:227], v[48:51], v[16:19], v[224:227]
  ds_read_b64_tr_b16 v[116:117], v164 offset:21632
  v_mfma_f32_16x16x32_bf16 v[224:227], v[60:63], v[20:23], v[224:227]
  v_mfma_f32_16x16x32_bf16 v[228:231], v[60:63], v[24:27], 0
  ds_read_b64_tr_b16 v[118:119], v164 offset:24192
  v_mfma_f32_16x16x32_bf16 v[228:231], v[48:51], v[20:23], v[228:231]
  ds_read_b128 v[84:87], v161 offset:16384
  v_mfma_f32_16x16x32_bf16 v[228:231], v[36:39], v[16:19], v[228:231]
  ds_read_b64_tr_b16 v[120:121], v164 offset:21568
  v_mfma_f32_16x16x32_bf16 v[232:235], v[36:39], v[20:23], 0
  ds_read_b64_tr_b16 v[122:123], v164 offset:24128
  v_mfma_f32_16x16x32_bf16 v[232:235], v[48:51], v[24:27], v[232:235]
  ds_read_b128 v[88:91], v161 offset:20480
  v_mfma_f32_16x16x32_bf16 v[232:235], v[60:63], v[28:31], v[232:235]
  ds_read_b64_tr_b16 v[124:125], v164 offset:26720
  v_mfma_f32_16x16x32_bf16 v[236:239], v[48:51], v[28:31], 0
  v_mfma_f32_16x16x32_bf16 v[236:239], v[36:39], v[24:27], v[236:239]
  ds_read_b64_tr_b16 v[126:127], v164 offset:29280
  v_mfma_f32_16x16x32_bf16 v[240:243], v[40:43], v[12:15], 0
  ds_read_b128 v[92:95], v161 offset:24576
  v_mfma_f32_16x16x32_bf16 v[240:243], v[52:55], v[16:19], v[240:243]
  ds_read_b64_tr_b16 v[128:129], v164 offset:26752
  v_mfma_f32_16x16x32_bf16 v[240:243], v[64:67], v[20:23], v[240:243]
  ds_read_b64_tr_b16 v[130:131], v164 offset:29312
  v_mfma_f32_16x16x32_bf16 v[244:247], v[64:67], v[24:27], 0
  ds_read_b128 v[96:99], v161 offset:28672
  v_mfma_f32_16x16x32_bf16 v[244:247], v[52:55], v[20:23], v[244:247]
  ds_read_b64_tr_b16 v[132:133], v164 offset:26688
  v_mfma_f32_16x16x32_bf16 v[244:247], v[40:43], v[16:19], v[244:247]
  ds_read_b64_tr_b16 v[134:135], v164 offset:29248
  v_mfma_f32_16x16x32_bf16 v[248:251], v[40:43], v[20:23], 0
  v_mfma_f32_16x16x32_bf16 v[248:251], v[52:55], v[24:27], v[248:251]
  v_mfma_f32_16x16x32_bf16 v[248:251], v[64:67], v[28:31], v[248:251]
  v_mfma_f32_16x16x32_bf16 v[252:255], v[52:55], v[28:31], 0
  v_mfma_f32_16x16x32_bf16 v[252:255], v[40:43], v[24:27], v[252:255]
  s_waitcnt lgkmcnt(0)
  s_barrier
  v_mfma_f32_16x16x32_bf16 v[176:179], v[112:115], v[68:71], v[176:179]
  v_mfma_f32_16x16x32_bf16 v[176:179], v[124:127], v[72:75], v[176:179]
  ds_read_b64_tr_b16 v[32:33], v164 offset:32864
  v_mfma_f32_16x16x32_bf16 v[180:183], v[124:127], v[76:79], v[180:183]
  v_mfma_f32_16x16x32_bf16 v[180:183], v[112:115], v[72:75], v[180:183]
  ds_read_b64_tr_b16 v[34:35], v164 offset:35424
  v_mfma_f32_16x16x32_bf16 v[180:183], v[100:103], v[68:71], v[180:183]
  v_mfma_f32_16x16x32_bf16 v[184:187], v[100:103], v[72:75], v[184:187]
  ds_read_b128 v[0:3], v160 offset:32768
  v_mfma_f32_16x16x32_bf16 v[184:187], v[112:115], v[76:79], v[184:187]
  v_mfma_f32_16x16x32_bf16 v[184:187], v[124:127], v[80:83], v[184:187]
  ds_read_b64_tr_b16 v[36:37], v164 offset:32896
  v_mfma_f32_16x16x32_bf16 v[188:191], v[124:127], v[84:87], v[188:191]
  v_mfma_f32_16x16x32_bf16 v[188:191], v[112:115], v[80:83], v[188:191]
  ds_read_b64_tr_b16 v[38:39], v164 offset:35456
  v_mfma_f32_16x16x32_bf16 v[188:191], v[100:103], v[76:79], v[188:191]
  v_mfma_f32_16x16x32_bf16 v[192:195], v[100:103], v[80:83], v[192:195]
  ds_read_b128 v[4:7], v160 offset:36864
  v_mfma_f32_16x16x32_bf16 v[192:195], v[112:115], v[84:87], v[192:195]
  ds_read_b64_tr_b16 v[40:41], v164 offset:32832
  v_mfma_f32_16x16x32_bf16 v[192:195], v[124:127], v[88:91], v[192:195]
  v_mfma_f32_16x16x32_bf16 v[196:199], v[124:127], v[92:95], v[196:199]
  ds_read_b64_tr_b16 v[42:43], v164 offset:35392
  v_mfma_f32_16x16x32_bf16 v[196:199], v[112:115], v[88:91], v[196:199]
  v_mfma_f32_16x16x32_bf16 v[196:199], v[100:103], v[84:87], v[196:199]
  ds_read_b128 v[8:11], v160 offset:40960
  v_mfma_f32_16x16x32_bf16 v[200:203], v[100:103], v[88:91], v[200:203]
  v_mfma_f32_16x16x32_bf16 v[200:203], v[112:115], v[92:95], v[200:203]
  ds_read_b64_tr_b16 v[44:45], v164 offset:37984
  v_mfma_f32_16x16x32_bf16 v[200:203], v[124:127], v[96:99], v[200:203]
  v_mfma_f32_16x16x32_bf16 v[204:207], v[112:115], v[96:99], v[204:207]
  ds_read_b64_tr_b16 v[46:47], v164 offset:40544
  v_mfma_f32_16x16x32_bf16 v[204:207], v[100:103], v[92:95], v[204:207]
  v_mfma_f32_16x16x32_bf16 v[208:211], v[116:119], v[68:71], v[208:211]
  ds_read_b128 v[12:15], v160 offset:45056
  v_mfma_f32_16x16x32_bf16 v[208:211], v[128:131], v[72:75], v[208:211]
  ds_read_b64_tr_b16 v[48:49], v164 offset:38016
  v_mfma_f32_16x16x32_bf16 v[212:215], v[128:131], v[76:79], v[212:215]
  v_mfma_f32_16x16x32_bf16 v[212:215], v[116:119], v[72:75], v[212:215]
  ds_read_b64_tr_b16 v[50:51], v164 offset:40576
  v_mfma_f32_16x16x32_bf16 v[212:215], v[104:107], v[68:71], v[212:215]
  v_mfma_f32_16x16x32_bf16 v[216:219], v[104:107], v[72:75], v[216:219]
  ds_read_b128 v[16:19], v160 offset:49152
  v_mfma_f32_16x16x32_bf16 v[216:219], v[116:119], v[76:79], v[216:219]
  v_mfma_f32_16x16x32_bf16 v[216:219], v[128:131], v[80:83], v[216:219]
  ds_read_b64_tr_b16 v[52:53], v164 offset:37952
  v_mfma_f32_16x16x32_bf16 v[220:223], v[128:131], v[84:87], v[220:223]
  v_mfma_f32_16x16x32_bf16 v[220:223], v[116:119], v[80:83], v[220:223]
  ds_read_b64_tr_b16 v[54:55], v164 offset:40512
  v_mfma_f32_16x16x32_bf16 v[220:223], v[104:107], v[76:79], v[220:223]
  v_mfma_f32_16x16x32_bf16 v[224:227], v[104:107], v[80:83], v[224:227]
  ds_read_b128 v[20:23], v160 offset:53248
  v_mfma_f32_16x16x32_bf16 v[224:227], v[116:119], v[84:87], v[224:227]
  v_mfma_f32_16x16x32_bf16 v[224:227], v[128:131], v[88:91], v[224:227]
  ds_read_b64_tr_b16 v[56:57], v164 offset:43104
  v_mfma_f32_16x16x32_bf16 v[228:231], v[128:131], v[92:95], v[228:231]
  ds_read_b64_tr_b16 v[58:59], v164 offset:45664
  v_mfma_f32_16x16x32_bf16 v[228:231], v[116:119], v[88:91], v[228:231]
  v_mfma_f32_16x16x32_bf16 v[228:231], v[104:107], v[84:87], v[228:231]
  ds_read_b128 v[24:27], v160 offset:57344
  v_mfma_f32_16x16x32_bf16 v[232:235], v[104:107], v[88:91], v[232:235]
  v_mfma_f32_16x16x32_bf16 v[232:235], v[116:119], v[92:95], v[232:235]
  ds_read_b64_tr_b16 v[60:61], v164 offset:43136
  v_mfma_f32_16x16x32_bf16 v[232:235], v[128:131], v[96:99], v[232:235]
  v_mfma_f32_16x16x32_bf16 v[236:239], v[116:119], v[96:99], v[236:239]
  ds_read_b64_tr_b16 v[62:63], v164 offset:45696
  v_mfma_f32_16x16x32_bf16 v[236:239], v[104:107], v[92:95], v[236:239]
  v_mfma_f32_16x16x32_bf16 v[240:243], v[108:111], v[80:83], v[240:243]
  ds_read_b128 v[28:31], v160 offset:61440
  v_mfma_f32_16x16x32_bf16 v[240:243], v[120:123], v[84:87], v[240:243]
  v_mfma_f32_16x16x32_bf16 v[240:243], v[132:135], v[88:91], v[240:243]
  ds_read_b64_tr_b16 v[64:65], v164 offset:43072
  v_mfma_f32_16x16x32_bf16 v[244:247], v[132:135], v[92:95], v[244:247]
  ds_read_b64_tr_b16 v[66:67], v164 offset:45632
  v_mfma_f32_16x16x32_bf16 v[244:247], v[120:123], v[88:91], v[244:247]
  v_mfma_f32_16x16x32_bf16 v[244:247], v[108:111], v[84:87], v[244:247]
  v_mfma_f32_16x16x32_bf16 v[248:251], v[108:111], v[88:91], v[248:251]
  v_mfma_f32_16x16x32_bf16 v[248:251], v[120:123], v[92:95], v[248:251]
  v_mfma_f32_16x16x32_bf16 v[248:251], v[132:135], v[96:99], v[248:251]
  v_mfma_f32_16x16x32_bf16 v[252:255], v[120:123], v[96:99], v[252:255]
  v_mfma_f32_16x16x32_bf16 v[252:255], v[108:111], v[92:95], v[252:255]
  s_waitcnt lgkmcnt(0)
  s_barrier
  v_mfma_f32_16x16x32_bf16 v[176:179], v[44:47], v[0:3], v[176:179]
  v_mfma_f32_16x16x32_bf16 v[176:179], v[56:59], v[4:7], v[176:179]
  ds_read_b64_tr_b16 v[100:101], v164 offset:49248
  v_mfma_f32_16x16x32_bf16 v[180:183], v[56:59], v[8:11], v[180:183]
  v_mfma_f32_16x16x32_bf16 v[180:183], v[44:47], v[4:7], v[180:183]
  ds_read_b64_tr_b16 v[102:103], v164 offset:51808
  v_mfma_f32_16x16x32_bf16 v[180:183], v[32:35], v[0:3], v[180:183]
  v_mfma_f32_16x16x32_bf16 v[184:187], v[32:35], v[4:7], v[184:187]
  ds_read_b128 v[68:71], v161 offset:32768
  v_mfma_f32_16x16x32_bf16 v[184:187], v[44:47], v[8:11], v[184:187]
  v_mfma_f32_16x16x32_bf16 v[184:187], v[56:59], v[12:15], v[184:187]
  ds_read_b64_tr_b16 v[104:105], v164 offset:49280
  v_mfma_f32_16x16x32_bf16 v[188:191], v[56:59], v[16:19], v[188:191]
  v_mfma_f32_16x16x32_bf16 v[188:191], v[44:47], v[12:15], v[188:191]
  ds_read_b64_tr_b16 v[106:107], v164 offset:51840
  v_mfma_f32_16x16x32_bf16 v[188:191], v[32:35], v[8:11], v[188:191]
  v_mfma_f32_16x16x32_bf16 v[192:195], v[32:35], v[12:15], v[192:195]
  ds_read_b128 v[72:75], v161 offset:36864
  v_mfma_f32_16x16x32_bf16 v[192:195], v[44:47], v[16:19], v[192:195]
  ds_read_b64_tr_b16 v[108:109], v164 offset:49216
  v_mfma_f32_16x16x32_bf16 v[192:195], v[56:59], v[20:23], v[192:195]
  v_mfma_f32_16x16x32_bf16 v[196:199], v[56:59], v[24:27], v[196:199]
  ds_read_b64_tr_b16 v[110:111], v164 offset:51776
  v_mfma_f32_16x16x32_bf16 v[196:199], v[44:47], v[20:23], v[196:199]
  v_mfma_f32_16x16x32_bf16 v[196:199], v[32:35], v[16:19], v[196:199]
  ds_read_b128 v[76:79], v161 offset:40960
  v_mfma_f32_16x16x32_bf16 v[200:203], v[32:35], v[20:23], v[200:203]
  v_mfma_f32_16x16x32_bf16 v[200:203], v[44:47], v[24:27], v[200:203]
  ds_read_b64_tr_b16 v[112:113], v164 offset:54368
  v_mfma_f32_16x16x32_bf16 v[200:203], v[56:59], v[28:31], v[200:203]
  v_mfma_f32_16x16x32_bf16 v[204:207], v[44:47], v[28:31], v[204:207]
  ds_read_b64_tr_b16 v[114:115], v164 offset:56928
  v_mfma_f32_16x16x32_bf16 v[204:207], v[32:35], v[24:27], v[204:207]
  v_mfma_f32_16x16x32_bf16 v[208:211], v[48:51], v[0:3], v[208:211]
  ds_read_b128 v[80:83], v161 offset:45056
  v_mfma_f32_16x16x32_bf16 v[208:211], v[60:63], v[4:7], v[208:211]
  ds_read_b64_tr_b16 v[116:117], v164 offset:54400
  v_mfma_f32_16x16x32_bf16 v[212:215], v[60:63], v[8:11], v[212:215]
  v_mfma_f32_16x16x32_bf16 v[212:215], v[48:51], v[4:7], v[212:215]
  ds_read_b64_tr_b16 v[118:119], v164 offset:56960
  v_mfma_f32_16x16x32_bf16 v[212:215], v[36:39], v[0:3], v[212:215]
  v_mfma_f32_16x16x32_bf16 v[216:219], v[36:39], v[4:7], v[216:219]
  ds_read_b128 v[84:87], v161 offset:49152
  v_mfma_f32_16x16x32_bf16 v[216:219], v[48:51], v[8:11], v[216:219]
  v_mfma_f32_16x16x32_bf16 v[216:219], v[60:63], v[12:15], v[216:219]
  ds_read_b64_tr_b16 v[120:121], v164 offset:54336
  v_mfma_f32_16x16x32_bf16 v[220:223], v[60:63], v[16:19], v[220:223]
  v_mfma_f32_16x16x32_bf16 v[220:223], v[48:51], v[12:15], v[220:223]
  ds_read_b64_tr_b16 v[122:123], v164 offset:56896
  v_mfma_f32_16x16x32_bf16 v[220:223], v[36:39], v[8:11], v[220:223]
  v_mfma_f32_16x16x32_bf16 v[224:227], v[36:39], v[12:15], v[224:227]
  ds_read_b128 v[88:91], v161 offset:53248
  v_mfma_f32_16x16x32_bf16 v[224:227], v[48:51], v[16:19], v[224:227]
  v_mfma_f32_16x16x32_bf16 v[224:227], v[60:63], v[20:23], v[224:227]
  ds_read_b64_tr_b16 v[124:125], v164 offset:59488
  v_mfma_f32_16x16x32_bf16 v[228:231], v[60:63], v[24:27], v[228:231]
  ds_read_b64_tr_b16 v[126:127], v164 offset:62048
  v_mfma_f32_16x16x32_bf16 v[228:231], v[48:51], v[20:23], v[228:231]
  v_mfma_f32_16x16x32_bf16 v[228:231], v[36:39], v[16:19], v[228:231]
  ds_read_b128 v[92:95], v161 offset:57344
  v_mfma_f32_16x16x32_bf16 v[232:235], v[36:39], v[20:23], v[232:235]
  v_mfma_f32_16x16x32_bf16 v[232:235], v[48:51], v[24:27], v[232:235]
  ds_read_b64_tr_b16 v[128:129], v164 offset:59520
  v_mfma_f32_16x16x32_bf16 v[232:235], v[60:63], v[28:31], v[232:235]
  v_mfma_f32_16x16x32_bf16 v[236:239], v[48:51], v[28:31], v[236:239]
  ds_read_b64_tr_b16 v[130:131], v164 offset:62080
  v_mfma_f32_16x16x32_bf16 v[236:239], v[36:39], v[24:27], v[236:239]
  v_mfma_f32_16x16x32_bf16 v[240:243], v[40:43], v[12:15], v[240:243]
  ds_read_b128 v[96:99], v161 offset:61440
  v_mfma_f32_16x16x32_bf16 v[240:243], v[52:55], v[16:19], v[240:243]
  v_mfma_f32_16x16x32_bf16 v[240:243], v[64:67], v[20:23], v[240:243]
  ds_read_b64_tr_b16 v[132:133], v164 offset:59456
  v_mfma_f32_16x16x32_bf16 v[244:247], v[64:67], v[24:27], v[244:247]
  ds_read_b64_tr_b16 v[134:135], v164 offset:62016
  v_mfma_f32_16x16x32_bf16 v[244:247], v[52:55], v[20:23], v[244:247]
  v_mfma_f32_16x16x32_bf16 v[244:247], v[40:43], v[16:19], v[244:247]
  v_mfma_f32_16x16x32_bf16 v[248:251], v[40:43], v[20:23], v[248:251]
  v_mfma_f32_16x16x32_bf16 v[248:251], v[52:55], v[24:27], v[248:251]
  v_mfma_f32_16x16x32_bf16 v[248:251], v[64:67], v[28:31], v[248:251]
  v_mfma_f32_16x16x32_bf16 v[252:255], v[52:55], v[28:31], v[252:255]
  v_mfma_f32_16x16x32_bf16 v[252:255], v[40:43], v[24:27], v[252:255]
  s_waitcnt lgkmcnt(0)
  s_barrier
  v_mfma_f32_16x16x32_bf16 v[176:179], v[112:115], v[68:71], v[176:179]
  v_mfma_f32_16x16x32_bf16 v[176:179], v[124:127], v[72:75], v[176:179]
  ds_read_b64_tr_b16 v[32:33], v164 offset:96
  v_mfma_f32_16x16x32_bf16 v[180:183], v[124:127], v[76:79], v[180:183]
  v_mfma_f32_16x16x32_bf16 v[180:183], v[112:115], v[72:75], v[180:183]
  ds_read_b64_tr_b16 v[34:35], v164 offset:2656
  v_mfma_f32_16x16x32_bf16 v[180:183], v[100:103], v[68:71], v[180:183]
  v_mfma_f32_16x16x32_bf16 v[184:187], v[100:103], v[72:75], v[184:187]
  ds_read_b128 v[0:3], v162 offset:0
  v_mfma_f32_16x16x32_bf16 v[184:187], v[112:115], v[76:79], v[184:187]
  v_mfma_f32_16x16x32_bf16 v[184:187], v[124:127], v[80:83], v[184:187]
  ds_read_b64_tr_b16 v[36:37], v164 offset:128
  v_mfma_f32_16x16x32_bf16 v[188:191], v[124:127], v[84:87], v[188:191]
  v_mfma_f32_16x16x32_bf16 v[188:191], v[112:115], v[80:83], v[188:191]
  ds_read_b64_tr_b16 v[38:39], v164 offset:2688
  v_mfma_f32_16x16x32_bf16 v[188:191], v[100:103], v[76:79], v[188:191]
  v_mfma_f32_16x16x32_bf16 v[192:195], v[100:103], v[80:83], v[192:195]
  ds_read_b128 v[4:7], v162 offset:4096
  v_mfma_f32_16x16x32_bf16 v[192:195], v[112:115], v[84:87], v[192:195]
  ds_read_b64_tr_b16 v[40:41], v164 offset:64
  v_mfma_f32_16x16x32_bf16 v[192:195], v[124:127], v[88:91], v[192:195]
  v_mfma_f32_16x16x32_bf16 v[196:199], v[124:127], v[92:95], v[196:199]
  ds_read_b64_tr_b16 v[42:43], v164 offset:2624
  v_mfma_f32_16x16x32_bf16 v[196:199], v[112:115], v[88:91], v[196:199]
  v_mfma_f32_16x16x32_bf16 v[196:199], v[100:103], v[84:87], v[196:199]
  ds_read_b128 v[8:11], v162 offset:8192
  v_mfma_f32_16x16x32_bf16 v[200:203], v[100:103], v[88:91], v[200:203]
  v_mfma_f32_16x16x32_bf16 v[200:203], v[112:115], v[92:95], v[200:203]
  ds_read_b64_tr_b16 v[44:45], v164 offset:5216
  v_mfma_f32_16x16x32_bf16 v[200:203], v[124:127], v[96:99], v[200:203]
  v_mfma_f32_16x16x32_bf16 v[204:207], v[112:115], v[96:99], v[204:207]
  ds_read_b64_tr_b16 v[46:47], v164 offset:7776
  v_mfma_f32_16x16x32_bf16 v[204:207], v[100:103], v[92:95], v[204:207]
  v_mfma_f32_16x16x32_bf16 v[208:211], v[116:119], v[68:71], v[208:211]
  ds_read_b128 v[12:15], v162 offset:12288
  v_mfma_f32_16x16x32_bf16 v[208:211], v[128:131], v[72:75], v[208:211]
  ds_read_b64_tr_b16 v[48:49], v164 offset:5248
  v_mfma_f32_16x16x32_bf16 v[212:215], v[128:131], v[76:79], v[212:215]
  v_mfma_f32_16x16x32_bf16 v[212:215], v[116:119], v[72:75], v[212:215]
  ds_read_b64_tr_b16 v[50:51], v164 offset:7808
  v_mfma_f32_16x16x32_bf16 v[212:215], v[104:107], v[68:71], v[212:215]
  v_mfma_f32_16x16x32_bf16 v[216:219], v[104:107], v[72:75], v[216:219]
  ds_read_b128 v[16:19], v162 offset:16384
  v_mfma_f32_16x16x32_bf16 v[216:219], v[116:119], v[76:79], v[216:219]
  v_mfma_f32_16x16x32_bf16 v[216:219], v[128:131], v[80:83], v[216:219]
  ds_read_b64_tr_b16 v[52:53], v164 offset:5184
  v_mfma_f32_16x16x32_bf16 v[220:223], v[128:131], v[84:87], v[220:223]
  v_mfma_f32_16x16x32_bf16 v[220:223], v[116:119], v[80:83], v[220:223]
  ds_read_b64_tr_b16 v[54:55], v164 offset:7744
  v_mfma_f32_16x16x32_bf16 v[220:223], v[104:107], v[76:79], v[220:223]
  v_mfma_f32_16x16x32_bf16 v[224:227], v[104:107], v[80:83], v[224:227]
  ds_read_b128 v[20:23], v162 offset:20480
  v_mfma_f32_16x16x32_bf16 v[224:227], v[116:119], v[84:87], v[224:227]
  v_mfma_f32_16x16x32_bf16 v[224:227], v[128:131], v[88:91], v[224:227]
  ds_read_b64_tr_b16 v[56:57], v164 offset:10336
  v_mfma_f32_16x16x32_bf16 v[228:231], v[128:131], v[92:95], v[228:231]
  ds_read_b64_tr_b16 v[58:59], v164 offset:12896
  v_mfma_f32_16x16x32_bf16 v[228:231], v[116:119], v[88:91], v[228:231]
  v_mfma_f32_16x16x32_bf16 v[228:231], v[104:107], v[84:87], v[228:231]
  ds_read_b128 v[24:27], v162 offset:24576
  v_mfma_f32_16x16x32_bf16 v[232:235], v[104:107], v[88:91], v[232:235]
  v_mfma_f32_16x16x32_bf16 v[232:235], v[116:119], v[92:95], v[232:235]
  ds_read_b64_tr_b16 v[60:61], v164 offset:10368
  v_mfma_f32_16x16x32_bf16 v[232:235], v[128:131], v[96:99], v[232:235]
  v_mfma_f32_16x16x32_bf16 v[236:239], v[116:119], v[96:99], v[236:239]
  ds_read_b64_tr_b16 v[62:63], v164 offset:12928
  v_mfma_f32_16x16x32_bf16 v[236:239], v[104:107], v[92:95], v[236:239]
  v_mfma_f32_16x16x32_bf16 v[240:243], v[108:111], v[80:83], v[240:243]
  ds_read_b128 v[28:31], v162 offset:28672
  v_mfma_f32_16x16x32_bf16 v[240:243], v[120:123], v[84:87], v[240:243]
  v_mfma_f32_16x16x32_bf16 v[240:243], v[132:135], v[88:91], v[240:243]
  ds_read_b64_tr_b16 v[64:65], v164 offset:10304
  v_mfma_f32_16x16x32_bf16 v[244:247], v[132:135], v[92:95], v[244:247]
  ds_read_b64_tr_b16 v[66:67], v164 offset:12864
  v_mfma_f32_16x16x32_bf16 v[244:247], v[120:123], v[88:91], v[244:247]
  v_mfma_f32_16x16x32_bf16 v[244:247], v[108:111], v[84:87], v[244:247]
  v_mfma_f32_16x16x32_bf16 v[248:251], v[108:111], v[88:91], v[248:251]
  v_mfma_f32_16x16x32_bf16 v[248:251], v[120:123], v[92:95], v[248:251]
  v_mfma_f32_16x16x32_bf16 v[248:251], v[132:135], v[96:99], v[248:251]
  v_mfma_f32_16x16x32_bf16 v[252:255], v[120:123], v[96:99], v[252:255]
  v_mfma_f32_16x16x32_bf16 v[252:255], v[108:111], v[92:95], v[252:255]
  s_waitcnt lgkmcnt(0)
  s_barrier
  v_mfma_f32_16x16x32_bf16 v[176:179], v[44:47], v[0:3], v[176:179]
  v_mfma_f32_16x16x32_bf16 v[176:179], v[56:59], v[4:7], v[176:179]
  ds_read_b64_tr_b16 v[100:101], v164 offset:16480
  v_mfma_f32_16x16x32_bf16 v[180:183], v[56:59], v[8:11], v[180:183]
  v_mfma_f32_16x16x32_bf16 v[180:183], v[44:47], v[4:7], v[180:183]
  ds_read_b64_tr_b16 v[102:103], v164 offset:19040
  v_mfma_f32_16x16x32_bf16 v[180:183], v[32:35], v[0:3], v[180:183]
  v_mfma_f32_16x16x32_bf16 v[184:187], v[32:35], v[4:7], v[184:187]
  ds_read_b128 v[68:71], v163 offset:0
  v_mfma_f32_16x16x32_bf16 v[184:187], v[44:47], v[8:11], v[184:187]
  v_mfma_f32_16x16x32_bf16 v[184:187], v[56:59], v[12:15], v[184:187]
  ds_read_b64_tr_b16 v[104:105], v164 offset:16512
  v_mfma_f32_16x16x32_bf16 v[188:191], v[56:59], v[16:19], v[188:191]
  v_mfma_f32_16x16x32_bf16 v[188:191], v[44:47], v[12:15], v[188:191]
  ds_read_b64_tr_b16 v[106:107], v164 offset:19072
  v_mfma_f32_16x16x32_bf16 v[188:191], v[32:35], v[8:11], v[188:191]
  v_mfma_f32_16x16x32_bf16 v[192:195], v[32:35], v[12:15], v[192:195]
  ds_read_b128 v[72:75], v163 offset:4096
  v_mfma_f32_16x16x32_bf16 v[192:195], v[44:47], v[16:19], v[192:195]
  ds_read_b64_tr_b16 v[108:109], v164 offset:16448
  v_mfma_f32_16x16x32_bf16 v[192:195], v[56:59], v[20:23], v[192:195]
  v_mfma_f32_16x16x32_bf16 v[196:199], v[56:59], v[24:27], v[196:199]
  ds_read_b64_tr_b16 v[110:111], v164 offset:19008
  v_mfma_f32_16x16x32_bf16 v[196:199], v[44:47], v[20:23], v[196:199]
  v_mfma_f32_16x16x32_bf16 v[196:199], v[32:35], v[16:19], v[196:199]
  ds_read_b128 v[76:79], v163 offset:8192
  v_mfma_f32_16x16x32_bf16 v[200:203], v[32:35], v[20:23], v[200:203]
  v_mfma_f32_16x16x32_bf16 v[200:203], v[44:47], v[24:27], v[200:203]
  ds_read_b64_tr_b16 v[112:113], v164 offset:21600
  v_mfma_f32_16x16x32_bf16 v[200:203], v[56:59], v[28:31], v[200:203]
  v_mfma_f32_16x16x32_bf16 v[204:207], v[44:47], v[28:31], v[204:207]
  ds_read_b64_tr_b16 v[114:115], v164 offset:24160
  v_mfma_f32_16x16x32_bf16 v[204:207], v[32:35], v[24:27], v[204:207]
  v_mfma_f32_16x16x32_bf16 v[208:211], v[48:51], v[0:3], v[208:211]
  ds_read_b128 v[80:83], v163 offset:12288
  v_mfma_f32_16x16x32_bf16 v[208:211], v[60:63], v[4:7], v[208:211]
  ds_read_b64_tr_b16 v[116:117], v164 offset:21632
  v_mfma_f32_16x16x32_bf16 v[212:215], v[60:63], v[8:11], v[212:215]
  v_mfma_f32_16x16x32_bf16 v[212:215], v[48:51], v[4:7], v[212:215]
  ds_read_b64_tr_b16 v[118:119], v164 offset:24192
  v_mfma_f32_16x16x32_bf16 v[212:215], v[36:39], v[0:3], v[212:215]
  v_mfma_f32_16x16x32_bf16 v[216:219], v[36:39], v[4:7], v[216:219]
  ds_read_b128 v[84:87], v163 offset:16384
  v_mfma_f32_16x16x32_bf16 v[216:219], v[48:51], v[8:11], v[216:219]
  v_mfma_f32_16x16x32_bf16 v[216:219], v[60:63], v[12:15], v[216:219]
  ds_read_b64_tr_b16 v[120:121], v164 offset:21568
  v_mfma_f32_16x16x32_bf16 v[220:223], v[60:63], v[16:19], v[220:223]
  v_mfma_f32_16x16x32_bf16 v[220:223], v[48:51], v[12:15], v[220:223]
  ds_read_b64_tr_b16 v[122:123], v164 offset:24128
  v_mfma_f32_16x16x32_bf16 v[220:223], v[36:39], v[8:11], v[220:223]
  v_mfma_f32_16x16x32_bf16 v[224:227], v[36:39], v[12:15], v[224:227]
  ds_read_b128 v[88:91], v163 offset:20480
  v_mfma_f32_16x16x32_bf16 v[224:227], v[48:51], v[16:19], v[224:227]
  v_mfma_f32_16x16x32_bf16 v[224:227], v[60:63], v[20:23], v[224:227]
  ds_read_b64_tr_b16 v[124:125], v164 offset:26720
  v_mfma_f32_16x16x32_bf16 v[228:231], v[60:63], v[24:27], v[228:231]
  ds_read_b64_tr_b16 v[126:127], v164 offset:29280
  v_mfma_f32_16x16x32_bf16 v[228:231], v[48:51], v[20:23], v[228:231]
  v_mfma_f32_16x16x32_bf16 v[228:231], v[36:39], v[16:19], v[228:231]
  ds_read_b128 v[92:95], v163 offset:24576
  v_mfma_f32_16x16x32_bf16 v[232:235], v[36:39], v[20:23], v[232:235]
  v_mfma_f32_16x16x32_bf16 v[232:235], v[48:51], v[24:27], v[232:235]
  ds_read_b64_tr_b16 v[128:129], v164 offset:26752
  v_mfma_f32_16x16x32_bf16 v[232:235], v[60:63], v[28:31], v[232:235]
  v_mfma_f32_16x16x32_bf16 v[236:239], v[48:51], v[28:31], v[236:239]
  ds_read_b64_tr_b16 v[130:131], v164 offset:29312
  v_mfma_f32_16x16x32_bf16 v[236:239], v[36:39], v[24:27], v[236:239]
  v_mfma_f32_16x16x32_bf16 v[240:243], v[40:43], v[12:15], v[240:243]
  ds_read_b128 v[96:99], v163 offset:28672
  v_mfma_f32_16x16x32_bf16 v[240:243], v[52:55], v[16:19], v[240:243]
  v_mfma_f32_16x16x32_bf16 v[240:243], v[64:67], v[20:23], v[240:243]
  ds_read_b64_tr_b16 v[132:133], v164 offset:26688
  v_mfma_f32_16x16x32_bf16 v[244:247], v[64:67], v[24:27], v[244:247]
  ds_read_b64_tr_b16 v[134:135], v164 offset:29248
  v_mfma_f32_16x16x32_bf16 v[244:247], v[52:55], v[20:23], v[244:247]
  v_mfma_f32_16x16x32_bf16 v[244:247], v[40:43], v[16:19], v[244:247]
  v_mfma_f32_16x16x32_bf16 v[248:251], v[40:43], v[20:23], v[248:251]
  v_mfma_f32_16x16x32_bf16 v[248:251], v[52:55], v[24:27], v[248:251]
  v_mfma_f32_16x16x32_bf16 v[248:251], v[64:67], v[28:31], v[248:251]
  v_mfma_f32_16x16x32_bf16 v[252:255], v[52:55], v[28:31], v[252:255]
  v_mfma_f32_16x16x32_bf16 v[252:255], v[40:43], v[24:27], v[252:255]
  s_waitcnt lgkmcnt(0)
  s_barrier
  v_mfma_f32_16x16x32_bf16 v[176:179], v[112:115], v[68:71], v[176:179]
  v_mfma_f32_16x16x32_bf16 v[176:179], v[124:127], v[72:75], v[176:179]
  ds_read_b64_tr_b16 v[32:33], v164 offset:32864
  v_mfma_f32_16x16x32_bf16 v[180:183], v[124:127], v[76:79], v[180:183]
  v_mfma_f32_16x16x32_bf16 v[180:183], v[112:115], v[72:75], v[180:183]
  ds_read_b64_tr_b16 v[34:35], v164 offset:35424
  v_mfma_f32_16x16x32_bf16 v[180:183], v[100:103], v[68:71], v[180:183]
  v_mfma_f32_16x16x32_bf16 v[184:187], v[100:103], v[72:75], v[184:187]
  ds_read_b128 v[0:3], v160 offset:0
  v_mfma_f32_16x16x32_bf16 v[184:187], v[112:115], v[76:79], v[184:187]
  v_mfma_f32_16x16x32_bf16 v[184:187], v[124:127], v[80:83], v[184:187]
  ds_read_b64_tr_b16 v[36:37], v164 offset:32896
  v_mfma_f32_16x16x32_bf16 v[188:191], v[124:127], v[84:87], v[188:191]
  v_mfma_f32_16x16x32_bf16 v[188:191], v[112:115], v[80:83], v[188:191]
  ds_read_b64_tr_b16 v[38:39], v164 offset:35456
  v_mfma_f32_16x16x32_bf16 v[188:191], v[100:103], v[76:79], v[188:191]
  v_mfma_f32_16x16x32_bf16 v[192:195], v[100:103], v[80:83], v[192:195]
  ds_read_b128 v[4:7], v160 offset:4096
  v_mfma_f32_16x16x32_bf16 v[192:195], v[112:115], v[84:87], v[192:195]
  ds_read_b64_tr_b16 v[40:41], v164 offset:32832
  v_mfma_f32_16x16x32_bf16 v[192:195], v[124:127], v[88:91], v[192:195]
  v_mfma_f32_16x16x32_bf16 v[196:199], v[124:127], v[92:95], v[196:199]
  ds_read_b64_tr_b16 v[42:43], v164 offset:35392
  v_mfma_f32_16x16x32_bf16 v[196:199], v[112:115], v[88:91], v[196:199]
  v_mfma_f32_16x16x32_bf16 v[196:199], v[100:103], v[84:87], v[196:199]
  ds_read_b128 v[8:11], v160 offset:8192
  v_mfma_f32_16x16x32_bf16 v[200:203], v[100:103], v[88:91], v[200:203]
  v_mfma_f32_16x16x32_bf16 v[200:203], v[112:115], v[92:95], v[200:203]
  ds_read_b64_tr_b16 v[44:45], v164 offset:37984
  v_mfma_f32_16x16x32_bf16 v[200:203], v[124:127], v[96:99], v[200:203]
  v_mfma_f32_16x16x32_bf16 v[204:207], v[112:115], v[96:99], v[204:207]
  ds_read_b64_tr_b16 v[46:47], v164 offset:40544
  v_mfma_f32_16x16x32_bf16 v[204:207], v[100:103], v[92:95], v[204:207]
  v_mfma_f32_16x16x32_bf16 v[208:211], v[116:119], v[68:71], v[208:211]
  ds_read_b128 v[12:15], v160 offset:12288
  v_mfma_f32_16x16x32_bf16 v[208:211], v[128:131], v[72:75], v[208:211]
  ds_read_b64_tr_b16 v[48:49], v164 offset:38016
  v_mfma_f32_16x16x32_bf16 v[212:215], v[128:131], v[76:79], v[212:215]
  v_mfma_f32_16x16x32_bf16 v[212:215], v[116:119], v[72:75], v[212:215]
  ds_read_b64_tr_b16 v[50:51], v164 offset:40576
  v_mfma_f32_16x16x32_bf16 v[212:215], v[104:107], v[68:71], v[212:215]
  v_mfma_f32_16x16x32_bf16 v[216:219], v[104:107], v[72:75], v[216:219]
  ds_read_b128 v[16:19], v160 offset:16384
  v_mfma_f32_16x16x32_bf16 v[216:219], v[116:119], v[76:79], v[216:219]
  v_mfma_f32_16x16x32_bf16 v[216:219], v[128:131], v[80:83], v[216:219]
  ds_read_b64_tr_b16 v[52:53], v164 offset:37952
  v_mfma_f32_16x16x32_bf16 v[220:223], v[128:131], v[84:87], v[220:223]
  v_mfma_f32_16x16x32_bf16 v[220:223], v[116:119], v[80:83], v[220:223]
  ds_read_b64_tr_b16 v[54:55], v164 offset:40512
  v_mfma_f32_16x16x32_bf16 v[220:223], v[104:107], v[76:79], v[220:223]
  v_mfma_f32_16x16x32_bf16 v[224:227], v[104:107], v[80:83], v[224:227]
  ds_read_b128 v[20:23], v160 offset:20480
L_pad_hi_1:
  s_cbranch_scc1 L_pad_hi_2
  v_mfma_f32_16x16x32_bf16 v[224:227], v[116:119], v[84:87], v[224:227]
  v_mfma_f32_16x16x32_bf16 v[224:227], v[128:131], v[88:91], v[224:227]
  ds_read_b64_tr_b16 v[56:57], v164 offset:43104
  v_mfma_f32_16x16x32_bf16 v[228:231], v[128:131], v[92:95], v[228:231]
  ds_read_b64_tr_b16 v[58:59], v164 offset:45664
  v_mfma_f32_16x16x32_bf16 v[228:231], v[116:119], v[88:91], v[228:231]
  v_mfma_f32_16x16x32_bf16 v[228:231], v[104:107], v[84:87], v[228:231]
  ds_read_b128 v[24:27], v160 offset:24576
  v_mfma_f32_16x16x32_bf16 v[232:235], v[104:107], v[88:91], v[232:235]
  v_mfma_f32_16x16x32_bf16 v[232:235], v[116:119], v[92:95], v[232:235]
  ds_read_b64_tr_b16 v[60:61], v164 offset:43136
  v_mfma_f32_16x16x32_bf16 v[232:235], v[128:131], v[96:99], v[232:235]
  v_mfma_f32_16x16x32_bf16 v[236:239], v[116:119], v[96:99], v[236:239]
  ds_read_b64_tr_b16 v[62:63], v164 offset:45696
  v_mfma_f32_16x16x32_bf16 v[236:239], v[104:107], v[92:95], v[236:239]
  v_mfma_f32_16x16x32_bf16 v[240:243], v[108:111], v[80:83], v[240:243]
  ds_read_b128 v[28:31], v160 offset:28672
  v_mfma_f32_16x16x32_bf16 v[240:243], v[120:123], v[84:87], v[240:243]
  v_mfma_f32_16x16x32_bf16 v[240:243], v[132:135], v[88:91], v[240:243]
  ds_read_b64_tr_b16 v[64:65], v164 offset:43072
  v_mfma_f32_16x16x32_bf16 v[244:247], v[132:135], v[92:95], v[244:247]
  ds_read_b64_tr_b16 v[66:67], v164 offset:45632
  v_mfma_f32_16x16x32_bf16 v[244:247], v[120:123], v[88:91], v[244:247]
  v_mfma_f32_16x16x32_bf16 v[244:247], v[108:111], v[84:87], v[244:247]
  v_mfma_f32_16x16x32_bf16 v[248:251], v[108:111], v[88:91], v[248:251]
  v_mfma_f32_16x16x32_bf16 v[248:251], v[120:123], v[92:95], v[248:251]
  v_mfma_f32_16x16x32_bf16 v[248:251], v[132:135], v[96:99], v[248:251]
  v_mfma_f32_16x16x32_bf16 v[252:255], v[120:123], v[96:99], v[252:255]
  v_mfma_f32_16x16x32_bf16 v[252:255], v[108:111], v[92:95], v[252:255]
  s_waitcnt lgkmcnt(0)
  s_barrier
  v_mfma_f32_16x16x32_bf16 v[176:179], v[44:47], v[0:3], v[176:179]
  v_mfma_f32_16x16x32_bf16 v[176:179], v[56:59], v[4:7], v[176:179]
  ds_read_b64_tr_b16 v[100:101], v164 offset:49248
  v_mfma_f32_16x16x32_bf16 v[180:183], v[56:59], v[8:11], v[180:183]
  v_mfma_f32_16x16x32_bf16 v[180:183], v[44:47], v[4:7], v[180:183]
  ds_read_b64_tr_b16 v[102:103], v164 offset:51808
  v_mfma_f32_16x16x32_bf16 v[180:183], v[32:35], v[0:3], v[180:183]
  v_mfma_f32_16x16x32_bf16 v[184:187], v[32:35], v[4:7], v[184:187]
  ds_read_b128 v[68:71], v161 offset:0
  v_mfma_f32_16x16x32_bf16 v[184:187], v[44:47], v[8:11], v[184:187]
  v_mfma_f32_16x16x32_bf16 v[184:187], v[56:59], v[12:15], v[184:187]
  ds_read_b64_tr_b16 v[104:105], v164 offset:49280
  v_mfma_f32_16x16x32_bf16 v[188:191], v[56:59], v[16:19], v[188:191]
  v_mfma_f32_16x16x32_bf16 v[188:191], v[44:47], v[12:15], v[188:191]
  ds_read_b64_tr_b16 v[106:107], v164 offset:51840
  v_mfma_f32_16x16x32_bf16 v[188:191], v[32:35], v[8:11], v[188:191]
  v_mfma_f32_16x16x32_bf16 v[192:195], v[32:35], v[12:15], v[192:195]
  ds_read_b128 v[72:75], v161 offset:4096
  v_mfma_f32_16x16x32_bf16 v[192:195], v[44:47], v[16:19], v[192:195]
  ds_read_b64_tr_b16 v[108:109], v164 offset:49216
  v_mfma_f32_16x16x32_bf16 v[192:195], v[56:59], v[20:23], v[192:195]
  v_mfma_f32_16x16x32_bf16 v[196:199], v[56:59], v[24:27], v[196:199]
  ds_read_b64_tr_b16 v[110:111], v164 offset:51776
  v_mfma_f32_16x16x32_bf16 v[196:199], v[44:47], v[20:23], v[196:199]
  v_mfma_f32_16x16x32_bf16 v[196:199], v[32:35], v[16:19], v[196:199]
  ds_read_b128 v[76:79], v161 offset:8192
  v_mfma_f32_16x16x32_bf16 v[200:203], v[32:35], v[20:23], v[200:203]
  v_mfma_f32_16x16x32_bf16 v[200:203], v[44:47], v[24:27], v[200:203]
  ds_read_b64_tr_b16 v[112:113], v164 offset:54368
  v_mfma_f32_16x16x32_bf16 v[200:203], v[56:59], v[28:31], v[200:203]
  v_mfma_f32_16x16x32_bf16 v[204:207], v[44:47], v[28:31], v[204:207]
  ds_read_b64_tr_b16 v[114:115], v164 offset:56928
  v_mfma_f32_16x16x32_bf16 v[204:207], v[32:35], v[24:27], v[204:207]
  v_mfma_f32_16x16x32_bf16 v[208:211], v[48:51], v[0:3], v[208:211]
  ds_read_b128 v[80:83], v161 offset:12288
  v_mfma_f32_16x16x32_bf16 v[208:211], v[60:63], v[4:7], v[208:211]
  ds_read_b64_tr_b16 v[116:117], v164 offset:54400
  v_mfma_f32_16x16x32_bf16 v[212:215], v[60:63], v[8:11], v[212:215]
  v_mfma_f32_16x16x32_bf16 v[212:215], v[48:51], v[4:7], v[212:215]
  ds_read_b64_tr_b16 v[118:119], v164 offset:56960
  v_mfma_f32_16x16x32_bf16 v[212:215], v[36:39], v[0:3], v[212:215]
  v_mfma_f32_16x16x32_bf16 v[216:219], v[36:39], v[4:7], v[216:219]
  ds_read_b128 v[84:87], v161 offset:16384
  v_mfma_f32_16x16x32_bf16 v[216:219], v[48:51], v[8:11], v[216:219]
  v_mfma_f32_16x16x32_bf16 v[216:219], v[60:63], v[12:15], v[216:219]
  ds_read_b64_tr_b16 v[120:121], v164 offset:54336
  v_mfma_f32_16x16x32_bf16 v[220:223], v[60:63], v[16:19], v[220:223]
  v_mfma_f32_16x16x32_bf16 v[220:223], v[48:51], v[12:15], v[220:223]
  ds_read_b64_tr_b16 v[122:123], v164 offset:56896
  v_mfma_f32_16x16x32_bf16 v[220:223], v[36:39], v[8:11], v[220:223]
  v_mfma_f32_16x16x32_bf16 v[224:227], v[36:39], v[12:15], v[224:227]
  ds_read_b128 v[88:91], v161 offset:20480
  v_mfma_f32_16x16x32_bf16 v[224:227], v[48:51], v[16:19], v[224:227]
  v_mfma_f32_16x16x32_bf16 v[224:227], v[60:63], v[20:23], v[224:227]
  ds_read_b64_tr_b16 v[124:125], v164 offset:59488
  v_mfma_f32_16x16x32_bf16 v[228:231], v[60:63], v[24:27], v[228:231]
  ds_read_b64_tr_b16 v[126:127], v164 offset:62048
  v_mfma_f32_16x16x32_bf16 v[228:231], v[48:51], v[20:23], v[228:231]
  v_mfma_f32_16x16x32_bf16 v[228:231], v[36:39], v[16:19], v[228:231]
  ds_read_b128 v[92:95], v161 offset:24576
  v_mfma_f32_16x16x32_bf16 v[232:235], v[36:39], v[20:23], v[232:235]
  v_mfma_f32_16x16x32_bf16 v[232:235], v[48:51], v[24:27], v[232:235]
  ds_read_b64_tr_b16 v[128:129], v164 offset:59520
  v_mfma_f32_16x16x32_bf16 v[232:235], v[60:63], v[28:31], v[232:235]
  v_mfma_f32_16x16x32_bf16 v[236:239], v[48:51], v[28:31], v[236:239]
  ds_read_b64_tr_b16 v[130:131], v164 offset:62080
  v_mfma_f32_16x16x32_bf16 v[236:239], v[36:39], v[24:27], v[236:239]
  v_mfma_f32_16x16x32_bf16 v[240:243], v[40:43], v[12:15], v[240:243]
  ds_read_b128 v[96:99], v161 offset:28672
  v_mfma_f32_16x16x32_bf16 v[240:243], v[52:55], v[16:19], v[240:243]
  v_mfma_f32_16x16x32_bf16 v[240:243], v[64:67], v[20:23], v[240:243]
  ds_read_b64_tr_b16 v[132:133], v164 offset:59456
  v_mfma_f32_16x16x32_bf16 v[244:247], v[64:67], v[24:27], v[244:247]
  ds_read_b64_tr_b16 v[134:135], v164 offset:62016
  v_mfma_f32_16x16x32_bf16 v[244:247], v[52:55], v[20:23], v[244:247]
  v_mfma_f32_16x16x32_bf16 v[244:247], v[40:43], v[16:19], v[244:247]
  v_mfma_f32_16x16x32_bf16 v[248:251], v[40:43], v[20:23], v[248:251]
  v_mfma_f32_16x16x32_bf16 v[248:251], v[52:55], v[24:27], v[248:251]
  v_mfma_f32_16x16x32_bf16 v[248:251], v[64:67], v[28:31], v[248:251]
  v_mfma_f32_16x16x32_bf16 v[252:255], v[52:55], v[28:31], v[252:255]
  v_mfma_f32_16x16x32_bf16 v[252:255], v[40:43], v[24:27], v[252:255]
  s_waitcnt lgkmcnt(0)
  s_barrier
  v_mfma_f32_16x16x32_bf16 v[176:179], v[112:115], v[68:71], v[176:179]
  v_mfma_f32_16x16x32_bf16 v[176:179], v[124:127], v[72:75], v[176:179]
  ds_read_b64_tr_b16 v[32:33], v164 offset:96
  v_mfma_f32_16x16x32_bf16 v[180:183], v[124:127], v[76:79], v[180:183]
  v_mfma_f32_16x16x32_bf16 v[180:183], v[112:115], v[72:75], v[180:183]
  ds_read_b64_tr_b16 v[34:35], v164 offset:2656
  v_mfma_f32_16x16x32_bf16 v[180:183], v[100:103], v[68:71], v[180:183]
  v_mfma_f32_16x16x32_bf16 v[184:187], v[100:103], v[72:75], v[184:187]
  ds_read_b128 v[0:3], v160 offset:32768
  v_mfma_f32_16x16x32_bf16 v[184:187], v[112:115], v[76:79], v[184:187]
  v_mfma_f32_16x16x32_bf16 v[184:187], v[124:127], v[80:83], v[184:187]
  ds_read_b64_tr_b16 v[36:37], v164 offset:128
  v_mfma_f32_16x16x32_bf16 v[188:191], v[124:127], v[84:87], v[188:191]
  v_mfma_f32_16x16x32_bf16 v[188:191], v[112:115], v[80:83], v[188:191]
  ds_read_b64_tr_b16 v[38:39], v164 offset:2688
  v_mfma_f32_16x16x32_bf16 v[188:191], v[100:103], v[76:79], v[188:191]
  v_mfma_f32_16x16x32_bf16 v[192:195], v[100:103], v[80:83], v[192:195]
  ds_read_b128 v[4:7], v160 offset:36864
  v_mfma_f32_16x16x32_bf16 v[192:195], v[112:115], v[84:87], v[192:195]
  ds_read_b64_tr_b16 v[40:41], v164 offset:64
  v_mfma_f32_16x16x32_bf16 v[192:195], v[124:127], v[88:91], v[192:195]
  v_mfma_f32_16x16x32_bf16 v[196:199], v[124:127], v[92:95], v[196:199]
  ds_read_b64_tr_b16 v[42:43], v164 offset:2624
  v_mfma_f32_16x16x32_bf16 v[196:199], v[112:115], v[88:91], v[196:199]
  v_mfma_f32_16x16x32_bf16 v[196:199], v[100:103], v[84:87], v[196:199]
  ds_read_b128 v[8:11], v160 offset:40960
  v_mfma_f32_16x16x32_bf16 v[200:203], v[100:103], v[88:91], v[200:203]
  v_mfma_f32_16x16x32_bf16 v[200:203], v[112:115], v[92:95], v[200:203]
  ds_read_b64_tr_b16 v[44:45], v164 offset:5216
  v_mfma_f32_16x16x32_bf16 v[200:203], v[124:127], v[96:99], v[200:203]
  v_mfma_f32_16x16x32_bf16 v[204:207], v[112:115], v[96:99], v[204:207]
  ds_read_b64_tr_b16 v[46:47], v164 offset:7776
  v_mfma_f32_16x16x32_bf16 v[204:207], v[100:103], v[92:95], v[204:207]
  v_mfma_f32_16x16x32_bf16 v[208:211], v[116:119], v[68:71], v[208:211]
  ds_read_b128 v[12:15], v160 offset:45056
  v_mfma_f32_16x16x32_bf16 v[208:211], v[128:131], v[72:75], v[208:211]
  ds_read_b64_tr_b16 v[48:49], v164 offset:5248
  v_mfma_f32_16x16x32_bf16 v[212:215], v[128:131], v[76:79], v[212:215]
  v_mfma_f32_16x16x32_bf16 v[212:215], v[116:119], v[72:75], v[212:215]
  ds_read_b64_tr_b16 v[50:51], v164 offset:7808
  v_mfma_f32_16x16x32_bf16 v[212:215], v[104:107], v[68:71], v[212:215]
  v_mfma_f32_16x16x32_bf16 v[216:219], v[104:107], v[72:75], v[216:219]
  ds_read_b128 v[16:19], v160 offset:49152
  v_mfma_f32_16x16x32_bf16 v[216:219], v[116:119], v[76:79], v[216:219]
  v_mfma_f32_16x16x32_bf16 v[216:219], v[128:131], v[80:83], v[216:219]
  ds_read_b64_tr_b16 v[52:53], v164 offset:5184
  v_mfma_f32_16x16x32_bf16 v[220:223], v[128:131], v[84:87], v[220:223]
  v_mfma_f32_16x16x32_bf16 v[220:223], v[116:119], v[80:83], v[220:223]
  ds_read_b64_tr_b16 v[54:55], v164 offset:7744
  v_mfma_f32_16x16x32_bf16 v[220:223], v[104:107], v[76:79], v[220:223]
  v_mfma_f32_16x16x32_bf16 v[224:227], v[104:107], v[80:83], v[224:227]
  ds_read_b128 v[20:23], v160 offset:53248
  v_mfma_f32_16x16x32_bf16 v[224:227], v[116:119], v[84:87], v[224:227]
  v_mfma_f32_16x16x32_bf16 v[224:227], v[128:131], v[88:91], v[224:227]
  ds_read_b64_tr_b16 v[56:57], v164 offset:10336
  v_mfma_f32_16x16x32_bf16 v[228:231], v[128:131], v[92:95], v[228:231]
  ds_read_b64_tr_b16 v[58:59], v164 offset:12896
  v_mfma_f32_16x16x32_bf16 v[228:231], v[116:119], v[88:91], v[228:231]
  v_mfma_f32_16x16x32_bf16 v[228:231], v[104:107], v[84:87], v[228:231]
  ds_read_b128 v[24:27], v160 offset:57344
  v_mfma_f32_16x16x32_bf16 v[232:235], v[104:107], v[88:91], v[232:235]
  v_mfma_f32_16x16x32_bf16 v[232:235], v[116:119], v[92:95], v[232:235]
  ds_read_b64_tr_b16 v[60:61], v164 offset:10368
  v_mfma_f32_16x16x32_bf16 v[232:235], v[128:131], v[96:99], v[232:235]
  v_mfma_f32_16x16x32_bf16 v[236:239], v[116:119], v[96:99], v[236:239]
  ds_read_b64_tr_b16 v[62:63], v164 offset:12928
  v_mfma_f32_16x16x32_bf16 v[236:239], v[104:107], v[92:95], v[236:239]
  v_mfma_f32_16x16x32_bf16 v[240:243], v[108:111], v[80:83], v[240:243]
  ds_read_b128 v[28:31], v160 offset:61440
  v_mfma_f32_16x16x32_bf16 v[240:243], v[120:123], v[84:87], v[240:243]
  v_mfma_f32_16x16x32_bf16 v[240:243], v[132:135], v[88:91], v[240:243]
  ds_read_b64_tr_b16 v[64:65], v164 offset:10304
  v_mfma_f32_16x16x32_bf16 v[244:247], v[132:135], v[92:95], v[244:247]
  ds_read_b64_tr_b16 v[66:67], v164 offset:12864
  v_mfma_f32_16x16x32_bf16 v[244:247], v[120:123], v[88:91], v[244:247]
  v_mfma_f32_16x16x32_bf16 v[244:247], v[108:111], v[84:87], v[244:247]
  v_mfma_f32_16x16x32_bf16 v[248:251], v[108:111], v[88:91], v[248:251]
  v_mfma_f32_16x16x32_bf16 v[248:251], v[120:123], v[92:95], v[248:251]
  v_mfma_f32_16x16x32_bf16 v[248:251], v[132:135], v[96:99], v[248:251]
  v_mfma_f32_16x16x32_bf16 v[252:255], v[120:123], v[96:99], v[252:255]
  v_mfma_f32_16x16x32_bf16 v[252:255], v[108:111], v[92:95], v[252:255]
  s_waitcnt lgkmcnt(0)
  s_barrier
  v_mfma_f32_16x16x32_bf16 v[176:179], v[44:47], v[0:3], v[176:179]
  v_mfma_f32_16x16x32_bf16 v[176:179], v[56:59], v[4:7], v[176:179]
  ds_read_b64_tr_b16 v[100:101], v164 offset:16480
  s_waitcnt vmcnt(0)
  v_mfma_f32_16x16x32_bf16 v[180:183], v[56:59], v[8:11], v[180:183]
  v_mfma_f32_16x16x32_bf16 v[180:183], v[44:47], v[4:7], v[180:183]
  ds_read_b64_tr_b16 v[102:103], v164 offset:19040
  v_mfma_f32_16x16x32_bf16 v[180:183], v[32:35], v[0:3], v[180:183]
  v_mfma_f32_16x16x32_bf16 v[184:187], v[32:35], v[4:7], v[184:187]
  ds_read_b128 v[68:71], v161 offset:32768
  v_lshlrev_b32 v136, 16, v136
  v_mfma_f32_16x16x32_bf16 v[184:187], v[44:47], v[8:11], v[184:187]
  v_mfma_f32_16x16x32_bf16 v[184:187], v[56:59], v[12:15], v[184:187]
  ds_read_b64_tr_b16 v[104:105], v164 offset:16512
  v_mfma_f32_16x16x32_bf16 v[188:191], v[56:59], v[16:19], v[188:191]
  v_mfma_f32_16x16x32_bf16 v[188:191], v[44:47], v[12:15], v[188:191]
  ds_read_b64_tr_b16 v[106:107], v164 offset:19072
  v_lshlrev_b32 v137, 16, v137
  v_mfma_f32_16x16x32_bf16 v[188:191], v[32:35], v[8:11], v[188:191]
  v_mfma_f32_16x16x32_bf16 v[192:195], v[32:35], v[12:15], v[192:195]
  ds_read_b128 v[72:75], v161 offset:36864
  v_mfma_f32_16x16x32_bf16 v[192:195], v[44:47], v[16:19], v[192:195]
  ds_read_b64_tr_b16 v[108:109], v164 offset:16448
  v_mfma_f32_16x16x32_bf16 v[192:195], v[56:59], v[20:23], v[192:195]
  v_lshlrev_b32 v138, 16, v138
  v_mfma_f32_16x16x32_bf16 v[196:199], v[56:59], v[24:27], v[196:199]
  ds_read_b64_tr_b16 v[110:111], v164 offset:19008
  v_mfma_f32_16x16x32_bf16 v[196:199], v[44:47], v[20:23], v[196:199]
  v_mfma_f32_16x16x32_bf16 v[196:199], v[32:35], v[16:19], v[196:199]
  ds_read_b128 v[76:79], v161 offset:40960
  v_mfma_f32_16x16x32_bf16 v[200:203], v[32:35], v[20:23], v[200:203]
  v_lshlrev_b32 v139, 16, v139
  v_mfma_f32_16x16x32_bf16 v[200:203], v[44:47], v[24:27], v[200:203]
  ds_read_b64_tr_b16 v[112:113], v164 offset:21600
  v_mfma_f32_16x16x32_bf16 v[200:203], v[56:59], v[28:31], v[200:203]
  v_mfma_f32_16x16x32_bf16 v[204:207], v[44:47], v[28:31], v[204:207]
  ds_read_b64_tr_b16 v[114:115], v164 offset:24160
  v_mfma_f32_16x16x32_bf16 v[204:207], v[32:35], v[24:27], v[204:207]
  v_add_f32 v137, 0x3727c5ac, v137
  v_mfma_f32_16x16x32_bf16 v[208:211], v[48:51], v[0:3], v[208:211]
  ds_read_b128 v[80:83], v161 offset:45056
  v_mfma_f32_16x16x32_bf16 v[208:211], v[60:63], v[4:7], v[208:211]
  ds_read_b64_tr_b16 v[116:117], v164 offset:21632
  v_mfma_f32_16x16x32_bf16 v[212:215], v[60:63], v[8:11], v[212:215]
  v_mfma_f32_16x16x32_bf16 v[212:215], v[48:51], v[4:7], v[212:215]
  ds_read_b64_tr_b16 v[118:119], v164 offset:24192
  v_rsq_f32 v137, v137
  v_mfma_f32_16x16x32_bf16 v[212:215], v[36:39], v[0:3], v[212:215]
  v_mfma_f32_16x16x32_bf16 v[216:219], v[36:39], v[4:7], v[216:219]
  ds_read_b128 v[84:87], v161 offset:49152
  v_mfma_f32_16x16x32_bf16 v[216:219], v[48:51], v[8:11], v[216:219]
  v_mfma_f32_16x16x32_bf16 v[216:219], v[60:63], v[12:15], v[216:219]
  ds_read_b64_tr_b16 v[120:121], v164 offset:21568
  v_mul_f32 v138, 0xbfb8aa3b, v138
  v_mfma_f32_16x16x32_bf16 v[220:223], v[60:63], v[16:19], v[220:223]
  v_mfma_f32_16x16x32_bf16 v[220:223], v[48:51], v[12:15], v[220:223]
  ds_read_b64_tr_b16 v[122:123], v164 offset:24128
  v_mfma_f32_16x16x32_bf16 v[220:223], v[36:39], v[8:11], v[220:223]
  v_mfma_f32_16x16x32_bf16 v[224:227], v[36:39], v[12:15], v[224:227]
  ds_read_b128 v[88:91], v161 offset:53248
  v_mul_f32 v139, 0xbfb8aa3b, v139
  v_mfma_f32_16x16x32_bf16 v[224:227], v[48:51], v[16:19], v[224:227]
  v_mfma_f32_16x16x32_bf16 v[224:227], v[60:63], v[20:23], v[224:227]
  ds_read_b64_tr_b16 v[124:125], v164 offset:26720
  v_mfma_f32_16x16x32_bf16 v[228:231], v[60:63], v[24:27], v[228:231]
  ds_read_b64_tr_b16 v[126:127], v164 offset:29280
  v_mfma_f32_16x16x32_bf16 v[228:231], v[48:51], v[20:23], v[228:231]
  v_mul_f32 v140, v138, v137
  v_mfma_f32_16x16x32_bf16 v[228:231], v[36:39], v[16:19], v[228:231]
  ds_read_b128 v[92:95], v161 offset:57344
  v_mfma_f32_16x16x32_bf16 v[232:235], v[36:39], v[20:23], v[232:235]
  v_mfma_f32_16x16x32_bf16 v[232:235], v[48:51], v[24:27], v[232:235]
  ds_read_b64_tr_b16 v[128:129], v164 offset:26752
  v_mfma_f32_16x16x32_bf16 v[232:235], v[60:63], v[28:31], v[232:235]
  v_fma_f32 v141, -v136, v140, v139
  v_mfma_f32_16x16x32_bf16 v[236:239], v[48:51], v[28:31], v[236:239]
  ds_read_b64_tr_b16 v[130:131], v164 offset:29312
  v_mfma_f32_16x16x32_bf16 v[236:239], v[36:39], v[24:27], v[236:239]
  v_mfma_f32_16x16x32_bf16 v[240:243], v[40:43], v[12:15], v[240:243]
  ds_read_b128 v[96:99], v161 offset:61440
  v_mfma_f32_16x16x32_bf16 v[240:243], v[52:55], v[16:19], v[240:243]
  v_mfma_f32_16x16x32_bf16 v[240:243], v[64:67], v[20:23], v[240:243]
  ds_read_b64_tr_b16 v[132:133], v164 offset:26688
  v_mfma_f32_16x16x32_bf16 v[244:247], v[64:67], v[24:27], v[244:247]
  ds_read_b64_tr_b16 v[134:135], v164 offset:29248
  v_mfma_f32_16x16x32_bf16 v[244:247], v[52:55], v[20:23], v[244:247]
  v_mfma_f32_16x16x32_bf16 v[244:247], v[40:43], v[16:19], v[244:247]
  v_mfma_f32_16x16x32_bf16 v[248:251], v[40:43], v[20:23], v[248:251]
  v_mfma_f32_16x16x32_bf16 v[248:251], v[52:55], v[24:27], v[248:251]
  v_mfma_f32_16x16x32_bf16 v[248:251], v[64:67], v[28:31], v[248:251]
  v_mfma_f32_16x16x32_bf16 v[252:255], v[52:55], v[28:31], v[252:255]
  v_mfma_f32_16x16x32_bf16 v[252:255], v[40:43], v[24:27], v[252:255]
  s_waitcnt lgkmcnt(0)
  s_barrier
  v_mfma_f32_16x16x32_bf16 v[176:179], v[112:115], v[68:71], v[176:179]
  v_mfma_f32_16x16x32_bf16 v[176:179], v[124:127], v[72:75], v[176:179]
  ds_read_b64_tr_b16 v[32:33], v164 offset:32864
  v_mfma_f32_16x16x32_bf16 v[180:183], v[124:127], v[76:79], v[180:183]
  v_mfma_f32_16x16x32_bf16 v[180:183], v[112:115], v[72:75], v[180:183]
  ds_read_b64_tr_b16 v[34:35], v164 offset:35424
  v_mfma_f32_16x16x32_bf16 v[180:183], v[100:103], v[68:71], v[180:183]
  v_mfma_f32_16x16x32_bf16 v[184:187], v[100:103], v[72:75], v[184:187]
  ds_read_b128 v[0:3], v162 offset:0
  v_mfma_f32_16x16x32_bf16 v[184:187], v[112:115], v[76:79], v[184:187]
  v_mfma_f32_16x16x32_bf16 v[184:187], v[124:127], v[80:83], v[184:187]
  ds_read_b64_tr_b16 v[36:37], v164 offset:32896
  v_mfma_f32_16x16x32_bf16 v[188:191], v[124:127], v[84:87], v[188:191]
  v_mfma_f32_16x16x32_bf16 v[188:191], v[112:115], v[80:83], v[188:191]
  ds_read_b64_tr_b16 v[38:39], v164 offset:35456
  v_mfma_f32_16x16x32_bf16 v[188:191], v[100:103], v[76:79], v[188:191]
  v_mfma_f32_16x16x32_bf16 v[192:195], v[100:103], v[80:83], v[192:195]
  ds_read_b128 v[4:7], v162 offset:4096
  v_mfma_f32_16x16x32_bf16 v[192:195], v[112:115], v[84:87], v[192:195]
  ds_read_b64_tr_b16 v[40:41], v164 offset:32832
  v_mfma_f32_16x16x32_bf16 v[192:195], v[124:127], v[88:91], v[192:195]
  v_mfma_f32_16x16x32_bf16 v[196:199], v[124:127], v[92:95], v[196:199]
  ds_read_b64_tr_b16 v[42:43], v164 offset:35392
  v_mfma_f32_16x16x32_bf16 v[196:199], v[112:115], v[88:91], v[196:199]
  v_mfma_f32_16x16x32_bf16 v[196:199], v[100:103], v[84:87], v[196:199]
  ds_read_b128 v[8:11], v162 offset:8192
  v_mfma_f32_16x16x32_bf16 v[200:203], v[100:103], v[88:91], v[200:203]
  v_mfma_f32_16x16x32_bf16 v[200:203], v[112:115], v[92:95], v[200:203]
  ds_read_b64_tr_b16 v[44:45], v164 offset:37984
  v_mfma_f32_16x16x32_bf16 v[200:203], v[124:127], v[96:99], v[200:203]
  v_mfma_f32_16x16x32_bf16 v[204:207], v[112:115], v[96:99], v[204:207]
  ds_read_b64_tr_b16 v[46:47], v164 offset:40544
  v_mfma_f32_16x16x32_bf16 v[204:207], v[100:103], v[92:95], v[204:207]
  v_mfma_f32_16x16x32_bf16 v[208:211], v[116:119], v[68:71], v[208:211]
  ds_read_b128 v[12:15], v162 offset:12288
  v_mfma_f32_16x16x32_bf16 v[208:211], v[128:131], v[72:75], v[208:211]
  ds_read_b64_tr_b16 v[48:49], v164 offset:38016
  v_mfma_f32_16x16x32_bf16 v[212:215], v[128:131], v[76:79], v[212:215]
  v_mfma_f32_16x16x32_bf16 v[212:215], v[116:119], v[72:75], v[212:215]
  ds_read_b64_tr_b16 v[50:51], v164 offset:40576
  v_mfma_f32_16x16x32_bf16 v[212:215], v[104:107], v[68:71], v[212:215]
  v_mfma_f32_16x16x32_bf16 v[216:219], v[104:107], v[72:75], v[216:219]
  ds_read_b128 v[16:19], v162 offset:16384
  v_mfma_f32_16x16x32_bf16 v[216:219], v[116:119], v[76:79], v[216:219]
  v_mfma_f32_16x16x32_bf16 v[216:219], v[128:131], v[80:83], v[216:219]
  ds_read_b64_tr_b16 v[52:53], v164 offset:37952
  v_mfma_f32_16x16x32_bf16 v[220:223], v[128:131], v[84:87], v[220:223]
  v_mfma_f32_16x16x32_bf16 v[220:223], v[116:119], v[80:83], v[220:223]
  ds_read_b64_tr_b16 v[54:55], v164 offset:40512
  v_mfma_f32_16x16x32_bf16 v[220:223], v[104:107], v[76:79], v[220:223]
  v_mfma_f32_16x16x32_bf16 v[224:227], v[104:107], v[80:83], v[224:227]
  ds_read_b128 v[20:23], v162 offset:20480
  v_mfma_f32_16x16x32_bf16 v[224:227], v[116:119], v[84:87], v[224:227]
  v_mfma_f32_16x16x32_bf16 v[224:227], v[128:131], v[88:91], v[224:227]
  ds_read_b64_tr_b16 v[56:57], v164 offset:43104
  v_mfma_f32_16x16x32_bf16 v[228:231], v[128:131], v[92:95], v[228:231]
  ds_read_b64_tr_b16 v[58:59], v164 offset:45664
  v_mfma_f32_16x16x32_bf16 v[228:231], v[116:119], v[88:91], v[228:231]
  v_mfma_f32_16x16x32_bf16 v[228:231], v[104:107], v[84:87], v[228:231]
  ds_read_b128 v[24:27], v162 offset:24576
  v_mfma_f32_16x16x32_bf16 v[232:235], v[104:107], v[88:91], v[232:235]
  v_mfma_f32_16x16x32_bf16 v[232:235], v[116:119], v[92:95], v[232:235]
  ds_read_b64_tr_b16 v[60:61], v164 offset:43136
  v_mfma_f32_16x16x32_bf16 v[232:235], v[128:131], v[96:99], v[232:235]
  v_mfma_f32_16x16x32_bf16 v[236:239], v[116:119], v[96:99], v[236:239]
  ds_read_b64_tr_b16 v[62:63], v164 offset:45696
  v_mfma_f32_16x16x32_bf16 v[236:239], v[104:107], v[92:95], v[236:239]
  v_mfma_f32_16x16x32_bf16 v[240:243], v[108:111], v[80:83], v[240:243]
  ds_read_b128 v[28:31], v162 offset:28672
  v_mfma_f32_16x16x32_bf16 v[240:243], v[120:123], v[84:87], v[240:243]
  v_mfma_f32_16x16x32_bf16 v[240:243], v[132:135], v[88:91], v[240:243]
  ds_read_b64_tr_b16 v[64:65], v164 offset:43072
  v_mfma_f32_16x16x32_bf16 v[244:247], v[132:135], v[92:95], v[244:247]
  ds_read_b64_tr_b16 v[66:67], v164 offset:45632
  v_mfma_f32_16x16x32_bf16 v[244:247], v[120:123], v[88:91], v[244:247]
  v_mfma_f32_16x16x32_bf16 v[244:247], v[108:111], v[84:87], v[244:247]
  v_mfma_f32_16x16x32_bf16 v[248:251], v[108:111], v[88:91], v[248:251]
  v_mfma_f32_16x16x32_bf16 v[248:251], v[120:123], v[92:95], v[248:251]
  v_mfma_f32_16x16x32_bf16 v[248:251], v[132:135], v[96:99], v[248:251]
  v_mfma_f32_16x16x32_bf16 v[252:255], v[120:123], v[96:99], v[252:255]
  v_mfma_f32_16x16x32_bf16 v[252:255], v[108:111], v[92:95], v[252:255]
  s_waitcnt lgkmcnt(0)
  s_barrier
  v_mfma_f32_16x16x32_bf16 v[176:179], v[44:47], v[0:3], v[176:179]
  v_mfma_f32_16x16x32_bf16 v[176:179], v[56:59], v[4:7], v[176:179]
  ds_read_b64_tr_b16 v[100:101], v164 offset:49248
  v_mfma_f32_16x16x32_bf16 v[180:183], v[56:59], v[8:11], v[180:183]
  v_mfma_f32_16x16x32_bf16 v[180:183], v[44:47], v[4:7], v[180:183]
  ds_read_b64_tr_b16 v[102:103], v164 offset:51808
  v_mfma_f32_16x16x32_bf16 v[180:183], v[32:35], v[0:3], v[180:183]
  v_mfma_f32_16x16x32_bf16 v[184:187], v[32:35], v[4:7], v[184:187]
  ds_read_b128 v[68:71], v163 offset:0
  v_mfma_f32_16x16x32_bf16 v[184:187], v[44:47], v[8:11], v[184:187]
  v_mfma_f32_16x16x32_bf16 v[184:187], v[56:59], v[12:15], v[184:187]
  ds_read_b64_tr_b16 v[104:105], v164 offset:49280
  v_mfma_f32_16x16x32_bf16 v[188:191], v[56:59], v[16:19], v[188:191]
  v_mfma_f32_16x16x32_bf16 v[188:191], v[44:47], v[12:15], v[188:191]
  ds_read_b64_tr_b16 v[106:107], v164 offset:51840
  v_mfma_f32_16x16x32_bf16 v[188:191], v[32:35], v[8:11], v[188:191]
  v_mfma_f32_16x16x32_bf16 v[192:195], v[32:35], v[12:15], v[192:195]
  ds_read_b128 v[72:75], v163 offset:4096
  v_mfma_f32_16x16x32_bf16 v[192:195], v[44:47], v[16:19], v[192:195]
  ds_read_b64_tr_b16 v[108:109], v164 offset:49216
  v_mfma_f32_16x16x32_bf16 v[192:195], v[56:59], v[20:23], v[192:195]
  v_mfma_f32_16x16x32_bf16 v[196:199], v[56:59], v[24:27], v[196:199]
  ds_read_b64_tr_b16 v[110:111], v164 offset:51776
  v_mfma_f32_16x16x32_bf16 v[196:199], v[44:47], v[20:23], v[196:199]
  v_mfma_f32_16x16x32_bf16 v[196:199], v[32:35], v[16:19], v[196:199]
  ds_read_b128 v[76:79], v163 offset:8192
  v_mfma_f32_16x16x32_bf16 v[200:203], v[32:35], v[20:23], v[200:203]
  v_mfma_f32_16x16x32_bf16 v[200:203], v[44:47], v[24:27], v[200:203]
  ds_read_b64_tr_b16 v[112:113], v164 offset:54368
  v_mfma_f32_16x16x32_bf16 v[200:203], v[56:59], v[28:31], v[200:203]
  v_mfma_f32_16x16x32_bf16 v[204:207], v[44:47], v[28:31], v[204:207]
  ds_read_b64_tr_b16 v[114:115], v164 offset:56928
  v_mfma_f32_16x16x32_bf16 v[204:207], v[32:35], v[24:27], v[204:207]
  v_mfma_f32_16x16x32_bf16 v[208:211], v[48:51], v[0:3], v[208:211]
  ds_read_b128 v[80:83], v163 offset:12288
  v_mfma_f32_16x16x32_bf16 v[208:211], v[60:63], v[4:7], v[208:211]
  ds_read_b64_tr_b16 v[116:117], v164 offset:54400
  v_mfma_f32_16x16x32_bf16 v[212:215], v[60:63], v[8:11], v[212:215]
  v_mfma_f32_16x16x32_bf16 v[212:215], v[48:51], v[4:7], v[212:215]
  ds_read_b64_tr_b16 v[118:119], v164 offset:56960
  v_mfma_f32_16x16x32_bf16 v[212:215], v[36:39], v[0:3], v[212:215]
  v_mfma_f32_16x16x32_bf16 v[216:219], v[36:39], v[4:7], v[216:219]
  ds_read_b128 v[84:87], v163 offset:16384
  v_mfma_f32_16x16x32_bf16 v[216:219], v[48:51], v[8:11], v[216:219]
  v_mfma_f32_16x16x32_bf16 v[216:219], v[60:63], v[12:15], v[216:219]
  ds_read_b64_tr_b16 v[120:121], v164 offset:54336
  v_mfma_f32_16x16x32_bf16 v[220:223], v[60:63], v[16:19], v[220:223]
  v_mfma_f32_16x16x32_bf16 v[220:223], v[48:51], v[12:15], v[220:223]
  ds_read_b64_tr_b16 v[122:123], v164 offset:56896
  v_mfma_f32_16x16x32_bf16 v[220:223], v[36:39], v[8:11], v[220:223]
  v_mfma_f32_16x16x32_bf16 v[224:227], v[36:39], v[12:15], v[224:227]
  ds_read_b128 v[88:91], v163 offset:20480
  v_mfma_f32_16x16x32_bf16 v[224:227], v[48:51], v[16:19], v[224:227]
  v_mfma_f32_16x16x32_bf16 v[224:227], v[60:63], v[20:23], v[224:227]
  ds_read_b64_tr_b16 v[124:125], v164 offset:59488
  v_mfma_f32_16x16x32_bf16 v[228:231], v[60:63], v[24:27], v[228:231]
  ds_read_b64_tr_b16 v[126:127], v164 offset:62048
  v_mfma_f32_16x16x32_bf16 v[228:231], v[48:51], v[20:23], v[228:231]
  v_mfma_f32_16x16x32_bf16 v[228:231], v[36:39], v[16:19], v[228:231]
  ds_read_b128 v[92:95], v163 offset:24576
  v_mfma_f32_16x16x32_bf16 v[232:235], v[36:39], v[20:23], v[232:235]
  v_mfma_f32_16x16x32_bf16 v[232:235], v[48:51], v[24:27], v[232:235]
  ds_read_b64_tr_b16 v[128:129], v164 offset:59520
  v_mfma_f32_16x16x32_bf16 v[232:235], v[60:63], v[28:31], v[232:235]
  v_mfma_f32_16x16x32_bf16 v[236:239], v[48:51], v[28:31], v[236:239]
  ds_read_b64_tr_b16 v[130:131], v164 offset:62080
  v_mfma_f32_16x16x32_bf16 v[236:239], v[36:39], v[24:27], v[236:239]
  v_mfma_f32_16x16x32_bf16 v[240:243], v[40:43], v[12:15], v[240:243]
  ds_read_b128 v[96:99], v163 offset:28672
  v_mfma_f32_16x16x32_bf16 v[240:243], v[52:55], v[16:19], v[240:243]
  v_mfma_f32_16x16x32_bf16 v[240:243], v[64:67], v[20:23], v[240:243]
  ds_read_b64_tr_b16 v[132:133], v164 offset:59456
  v_mfma_f32_16x16x32_bf16 v[244:247], v[64:67], v[24:27], v[244:247]
  ds_read_b64_tr_b16 v[134:135], v164 offset:62016
  v_mfma_f32_16x16x32_bf16 v[244:247], v[52:55], v[20:23], v[244:247]
  v_mfma_f32_16x16x32_bf16 v[244:247], v[40:43], v[16:19], v[244:247]
  v_mfma_f32_16x16x32_bf16 v[248:251], v[40:43], v[20:23], v[248:251]
  v_mfma_f32_16x16x32_bf16 v[248:251], v[52:55], v[24:27], v[248:251]
  v_mfma_f32_16x16x32_bf16 v[248:251], v[64:67], v[28:31], v[248:251]
  v_mfma_f32_16x16x32_bf16 v[252:255], v[52:55], v[28:31], v[252:255]
  v_mfma_f32_16x16x32_bf16 v[252:255], v[40:43], v[24:27], v[252:255]
  s_waitcnt lgkmcnt(0)
  s_barrier
  v_mfma_f32_16x16x32_bf16 v[176:179], v[112:115], v[68:71], v[176:179]
  v_mfma_f32_16x16x32_bf16 v[176:179], v[124:127], v[72:75], v[176:179]
  ds_read_b64_tr_b16 v[32:33], v164 offset:96
  v_mfma_f32_16x16x32_bf16 v[180:183], v[124:127], v[76:79], v[180:183]
  v_mfma_f32_16x16x32_bf16 v[180:183], v[112:115], v[72:75], v[180:183]
  ds_read_b64_tr_b16 v[34:35], v164 offset:2656
  v_mfma_f32_16x16x32_bf16 v[180:183], v[100:103], v[68:71], v[180:183]
  v_mfma_f32_16x16x32_bf16 v[184:187], v[100:103], v[72:75], v[184:187]
  ds_read_b128 v[0:3], v160 offset:0
  v_mfma_f32_16x16x32_bf16 v[184:187], v[112:115], v[76:79], v[184:187]
  v_mfma_f32_16x16x32_bf16 v[184:187], v[124:127], v[80:83], v[184:187]
  ds_read_b64_tr_b16 v[36:37], v164 offset:128
  v_mfma_f32_16x16x32_bf16 v[188:191], v[124:127], v[84:87], v[188:191]
  v_mfma_f32_16x16x32_bf16 v[188:191], v[112:115], v[80:83], v[188:191]
  ds_read_b64_tr_b16 v[38:39], v164 offset:2688
  v_mfma_f32_16x16x32_bf16 v[188:191], v[100:103], v[76:79], v[188:191]
  v_mfma_f32_16x16x32_bf16 v[192:195], v[100:103], v[80:83], v[192:195]
  ds_read_b128 v[4:7], v160 offset:4096
  v_mfma_f32_16x16x32_bf16 v[192:195], v[112:115], v[84:87], v[192:195]
  ds_read_b64_tr_b16 v[40:41], v164 offset:64
  v_mfma_f32_16x16x32_bf16 v[192:195], v[124:127], v[88:91], v[192:195]
  v_mfma_f32_16x16x32_bf16 v[196:199], v[124:127], v[92:95], v[196:199]
  ds_read_b64_tr_b16 v[42:43], v164 offset:2624
  v_mfma_f32_16x16x32_bf16 v[196:199], v[112:115], v[88:91], v[196:199]
  v_mfma_f32_16x16x32_bf16 v[196:199], v[100:103], v[84:87], v[196:199]
  ds_read_b128 v[8:11], v160 offset:8192
  v_mfma_f32_16x16x32_bf16 v[200:203], v[100:103], v[88:91], v[200:203]
  v_mfma_f32_16x16x32_bf16 v[200:203], v[112:115], v[92:95], v[200:203]
  ds_read_b64_tr_b16 v[44:45], v164 offset:5216
  v_mfma_f32_16x16x32_bf16 v[200:203], v[124:127], v[96:99], v[200:203]
  v_mfma_f32_16x16x32_bf16 v[204:207], v[112:115], v[96:99], v[204:207]
  ds_read_b64_tr_b16 v[46:47], v164 offset:7776
  v_mfma_f32_16x16x32_bf16 v[204:207], v[100:103], v[92:95], v[204:207]
  v_mfma_f32_16x16x32_bf16 v[208:211], v[116:119], v[68:71], v[208:211]
  ds_read_b128 v[12:15], v160 offset:12288
  v_mfma_f32_16x16x32_bf16 v[208:211], v[128:131], v[72:75], v[208:211]
  ds_read_b64_tr_b16 v[48:49], v164 offset:5248
  v_mfma_f32_16x16x32_bf16 v[212:215], v[128:131], v[76:79], v[212:215]
  v_mfma_f32_16x16x32_bf16 v[212:215], v[116:119], v[72:75], v[212:215]
  ds_read_b64_tr_b16 v[50:51], v164 offset:7808
  v_mfma_f32_16x16x32_bf16 v[212:215], v[104:107], v[68:71], v[212:215]
  v_mfma_f32_16x16x32_bf16 v[216:219], v[104:107], v[72:75], v[216:219]
  ds_read_b128 v[16:19], v160 offset:16384
  v_mfma_f32_16x16x32_bf16 v[216:219], v[116:119], v[76:79], v[216:219]
  v_mfma_f32_16x16x32_bf16 v[216:219], v[128:131], v[80:83], v[216:219]
  ds_read_b64_tr_b16 v[52:53], v164 offset:5184
  v_mfma_f32_16x16x32_bf16 v[220:223], v[128:131], v[84:87], v[220:223]
  v_mfma_f32_16x16x32_bf16 v[220:223], v[116:119], v[80:83], v[220:223]
  ds_read_b64_tr_b16 v[54:55], v164 offset:7744
  v_mfma_f32_16x16x32_bf16 v[220:223], v[104:107], v[76:79], v[220:223]
  v_mfma_f32_16x16x32_bf16 v[224:227], v[104:107], v[80:83], v[224:227]
  ds_read_b128 v[20:23], v160 offset:20480
  v_mfma_f32_16x16x32_bf16 v[224:227], v[116:119], v[84:87], v[224:227]
  v_mfma_f32_16x16x32_bf16 v[224:227], v[128:131], v[88:91], v[224:227]
  ds_read_b64_tr_b16 v[56:57], v164 offset:10336
  v_mfma_f32_16x16x32_bf16 v[228:231], v[128:131], v[92:95], v[228:231]
  ds_read_b64_tr_b16 v[58:59], v164 offset:12896
  v_mfma_f32_16x16x32_bf16 v[228:231], v[116:119], v[88:91], v[228:231]
  v_mfma_f32_16x16x32_bf16 v[228:231], v[104:107], v[84:87], v[228:231]
  ds_read_b128 v[24:27], v160 offset:24576
  v_mfma_f32_16x16x32_bf16 v[232:235], v[104:107], v[88:91], v[232:235]
  v_mfma_f32_16x16x32_bf16 v[232:235], v[116:119], v[92:95], v[232:235]
  ds_read_b64_tr_b16 v[60:61], v164 offset:10368
  v_mfma_f32_16x16x32_bf16 v[232:235], v[128:131], v[96:99], v[232:235]
L_pad_hi_2:
  s_cbranch_scc1 L_warm_hi
  v_mfma_f32_16x16x32_bf16 v[236:239], v[116:119], v[96:99], v[236:239]
  ds_read_b64_tr_b16 v[62:63], v164 offset:12928
  v_mfma_f32_16x16x32_bf16 v[236:239], v[104:107], v[92:95], v[236:239]
  v_mfma_f32_16x16x32_bf16 v[240:243], v[108:111], v[80:83], v[240:243]
  ds_read_b128 v[28:31], v160 offset:28672
  v_mfma_f32_16x16x32_bf16 v[240:243], v[120:123], v[84:87], v[240:243]
  v_mfma_f32_16x16x32_bf16 v[240:243], v[132:135], v[88:91], v[240:243]
  ds_read_b64_tr_b16 v[64:65], v164 offset:10304
  v_mfma_f32_16x16x32_bf16 v[244:247], v[132:135], v[92:95], v[244:247]
  ds_read_b64_tr_b16 v[66:67], v164 offset:12864
  v_mfma_f32_16x16x32_bf16 v[244:247], v[120:123], v[88:91], v[244:247]
  v_mfma_f32_16x16x32_bf16 v[244:247], v[108:111], v[84:87], v[244:247]
  v_mfma_f32_16x16x32_bf16 v[248:251], v[108:111], v[88:91], v[248:251]
  v_mfma_f32_16x16x32_bf16 v[248:251], v[120:123], v[92:95], v[248:251]
  v_mfma_f32_16x16x32_bf16 v[248:251], v[132:135], v[96:99], v[248:251]
  v_mfma_f32_16x16x32_bf16 v[252:255], v[120:123], v[96:99], v[252:255]
  v_mfma_f32_16x16x32_bf16 v[252:255], v[108:111], v[92:95], v[252:255]
  s_waitcnt lgkmcnt(0)
  s_barrier
  v_mfma_f32_16x16x32_bf16 v[176:179], v[44:47], v[0:3], v[176:179]
  v_mfma_f32_16x16x32_bf16 v[176:179], v[56:59], v[4:7], v[176:179]
  ds_read_b64_tr_b16 v[100:101], v164 offset:16480
  v_mfma_f32_16x16x32_bf16 v[180:183], v[56:59], v[8:11], v[180:183]
  v_mfma_f32_16x16x32_bf16 v[180:183], v[44:47], v[4:7], v[180:183]
  ds_read_b64_tr_b16 v[102:103], v164 offset:19040
  v_mfma_f32_16x16x32_bf16 v[180:183], v[32:35], v[0:3], v[180:183]
  v_mfma_f32_16x16x32_bf16 v[184:187], v[32:35], v[4:7], v[184:187]
  ds_read_b128 v[68:71], v161 offset:0
  v_mfma_f32_16x16x32_bf16 v[184:187], v[44:47], v[8:11], v[184:187]
  v_mfma_f32_16x16x32_bf16 v[184:187], v[56:59], v[12:15], v[184:187]
  ds_read_b64_tr_b16 v[104:105], v164 offset:16512
  v_mfma_f32_16x16x32_bf16 v[188:191], v[56:59], v[16:19], v[188:191]
  v_mfma_f32_16x16x32_bf16 v[188:191], v[44:47], v[12:15], v[188:191]
  ds_read_b64_tr_b16 v[106:107], v164 offset:19072
  v_mfma_f32_16x16x32_bf16 v[188:191], v[32:35], v[8:11], v[188:191]
  v_mfma_f32_16x16x32_bf16 v[192:195], v[32:35], v[12:15], v[192:195]
  ds_read_b128 v[72:75], v161 offset:4096
  v_mfma_f32_16x16x32_bf16 v[192:195], v[44:47], v[16:19], v[192:195]
  ds_read_b64_tr_b16 v[108:109], v164 offset:16448
  v_mfma_f32_16x16x32_bf16 v[192:195], v[56:59], v[20:23], v[192:195]
  v_mfma_f32_16x16x32_bf16 v[196:199], v[56:59], v[24:27], v[196:199]
  ds_read_b64_tr_b16 v[110:111], v164 offset:19008
  v_mfma_f32_16x16x32_bf16 v[196:199], v[44:47], v[20:23], v[196:199]
  v_mfma_f32_16x16x32_bf16 v[196:199], v[32:35], v[16:19], v[196:199]
  ds_read_b128 v[76:79], v161 offset:8192
  v_mfma_f32_16x16x32_bf16 v[200:203], v[32:35], v[20:23], v[200:203]
  v_mfma_f32_16x16x32_bf16 v[200:203], v[44:47], v[24:27], v[200:203]
  ds_read_b64_tr_b16 v[112:113], v164 offset:21600
  v_mfma_f32_16x16x32_bf16 v[200:203], v[56:59], v[28:31], v[200:203]
  v_mfma_f32_16x16x32_bf16 v[204:207], v[44:47], v[28:31], v[204:207]
  ds_read_b64_tr_b16 v[114:115], v164 offset:24160
  v_mfma_f32_16x16x32_bf16 v[204:207], v[32:35], v[24:27], v[204:207]
  v_mfma_f32_16x16x32_bf16 v[208:211], v[48:51], v[0:3], v[208:211]
  ds_read_b128 v[80:83], v161 offset:12288
  v_mfma_f32_16x16x32_bf16 v[208:211], v[60:63], v[4:7], v[208:211]
  ds_read_b64_tr_b16 v[116:117], v164 offset:21632
  v_mfma_f32_16x16x32_bf16 v[212:215], v[60:63], v[8:11], v[212:215]
  v_mfma_f32_16x16x32_bf16 v[212:215], v[48:51], v[4:7], v[212:215]
  ds_read_b64_tr_b16 v[118:119], v164 offset:24192
  v_mfma_f32_16x16x32_bf16 v[212:215], v[36:39], v[0:3], v[212:215]
  v_mfma_f32_16x16x32_bf16 v[216:219], v[36:39], v[4:7], v[216:219]
  ds_read_b128 v[84:87], v161 offset:16384
  v_mfma_f32_16x16x32_bf16 v[216:219], v[48:51], v[8:11], v[216:219]
  v_mfma_f32_16x16x32_bf16 v[216:219], v[60:63], v[12:15], v[216:219]
  ds_read_b64_tr_b16 v[120:121], v164 offset:21568
  v_mfma_f32_16x16x32_bf16 v[220:223], v[60:63], v[16:19], v[220:223]
  v_mfma_f32_16x16x32_bf16 v[220:223], v[48:51], v[12:15], v[220:223]
  ds_read_b64_tr_b16 v[122:123], v164 offset:24128
  v_mfma_f32_16x16x32_bf16 v[220:223], v[36:39], v[8:11], v[220:223]
  v_mfma_f32_16x16x32_bf16 v[224:227], v[36:39], v[12:15], v[224:227]
  ds_read_b128 v[88:91], v161 offset:20480
  v_mfma_f32_16x16x32_bf16 v[224:227], v[48:51], v[16:19], v[224:227]
  v_mfma_f32_16x16x32_bf16 v[224:227], v[60:63], v[20:23], v[224:227]
  ds_read_b64_tr_b16 v[124:125], v164 offset:26720
  v_mfma_f32_16x16x32_bf16 v[228:231], v[60:63], v[24:27], v[228:231]
  ds_read_b64_tr_b16 v[126:127], v164 offset:29280
  v_mfma_f32_16x16x32_bf16 v[228:231], v[48:51], v[20:23], v[228:231]
  v_mfma_f32_16x16x32_bf16 v[228:231], v[36:39], v[16:19], v[228:231]
  ds_read_b128 v[92:95], v161 offset:24576
  v_mfma_f32_16x16x32_bf16 v[232:235], v[36:39], v[20:23], v[232:235]
  v_mfma_f32_16x16x32_bf16 v[232:235], v[48:51], v[24:27], v[232:235]
  ds_read_b64_tr_b16 v[128:129], v164 offset:26752
  v_mfma_f32_16x16x32_bf16 v[232:235], v[60:63], v[28:31], v[232:235]
  v_mfma_f32_16x16x32_bf16 v[236:239], v[48:51], v[28:31], v[236:239]
  ds_read_b64_tr_b16 v[130:131], v164 offset:29312
  v_mfma_f32_16x16x32_bf16 v[236:239], v[36:39], v[24:27], v[236:239]
  v_mfma_f32_16x16x32_bf16 v[240:243], v[40:43], v[12:15], v[240:243]
  ds_read_b128 v[96:99], v161 offset:28672
  v_mfma_f32_16x16x32_bf16 v[240:243], v[52:55], v[16:19], v[240:243]
  v_mfma_f32_16x16x32_bf16 v[240:243], v[64:67], v[20:23], v[240:243]
  ds_read_b64_tr_b16 v[132:133], v164 offset:26688
  v_mfma_f32_16x16x32_bf16 v[244:247], v[64:67], v[24:27], v[244:247]
  ds_read_b64_tr_b16 v[134:135], v164 offset:29248
  v_mfma_f32_16x16x32_bf16 v[244:247], v[52:55], v[20:23], v[244:247]
  v_mfma_f32_16x16x32_bf16 v[244:247], v[40:43], v[16:19], v[244:247]
  v_mfma_f32_16x16x32_bf16 v[248:251], v[40:43], v[20:23], v[248:251]
  v_mfma_f32_16x16x32_bf16 v[248:251], v[52:55], v[24:27], v[248:251]
  v_mfma_f32_16x16x32_bf16 v[248:251], v[64:67], v[28:31], v[248:251]
  v_mfma_f32_16x16x32_bf16 v[252:255], v[52:55], v[28:31], v[252:255]
  v_mfma_f32_16x16x32_bf16 v[252:255], v[40:43], v[24:27], v[252:255]
  s_waitcnt lgkmcnt(0)
  s_barrier
  v_mfma_f32_16x16x32_bf16 v[176:179], v[112:115], v[68:71], v[176:179]
  v_mfma_f32_16x16x32_bf16 v[176:179], v[124:127], v[72:75], v[176:179]
  ds_read_b64_tr_b16 v[32:33], v164 offset:32864
  v_mfma_f32_16x16x32_bf16 v[180:183], v[124:127], v[76:79], v[180:183]
  v_mfma_f32_16x16x32_bf16 v[180:183], v[112:115], v[72:75], v[180:183]
  ds_read_b64_tr_b16 v[34:35], v164 offset:35424
  v_mfma_f32_16x16x32_bf16 v[180:183], v[100:103], v[68:71], v[180:183]
  v_mfma_f32_16x16x32_bf16 v[184:187], v[100:103], v[72:75], v[184:187]
  ds_read_b128 v[0:3], v160 offset:32768
  v_mfma_f32_16x16x32_bf16 v[184:187], v[112:115], v[76:79], v[184:187]
  v_mfma_f32_16x16x32_bf16 v[184:187], v[124:127], v[80:83], v[184:187]
  ds_read_b64_tr_b16 v[36:37], v164 offset:32896
  v_mfma_f32_16x16x32_bf16 v[188:191], v[124:127], v[84:87], v[188:191]
  v_mfma_f32_16x16x32_bf16 v[188:191], v[112:115], v[80:83], v[188:191]
  ds_read_b64_tr_b16 v[38:39], v164 offset:35456
  v_mfma_f32_16x16x32_bf16 v[188:191], v[100:103], v[76:79], v[188:191]
  v_mfma_f32_16x16x32_bf16 v[192:195], v[100:103], v[80:83], v[192:195]
  ds_read_b128 v[4:7], v160 offset:36864
  v_mfma_f32_16x16x32_bf16 v[192:195], v[112:115], v[84:87], v[192:195]
  ds_read_b64_tr_b16 v[40:41], v164 offset:32832
  v_mfma_f32_16x16x32_bf16 v[192:195], v[124:127], v[88:91], v[192:195]
  v_mfma_f32_16x16x32_bf16 v[196:199], v[124:127], v[92:95], v[196:199]
  ds_read_b64_tr_b16 v[42:43], v164 offset:35392
  v_mfma_f32_16x16x32_bf16 v[196:199], v[112:115], v[88:91], v[196:199]
  v_mfma_f32_16x16x32_bf16 v[196:199], v[100:103], v[84:87], v[196:199]
  ds_read_b128 v[8:11], v160 offset:40960
  v_mfma_f32_16x16x32_bf16 v[200:203], v[100:103], v[88:91], v[200:203]
  v_mfma_f32_16x16x32_bf16 v[200:203], v[112:115], v[92:95], v[200:203]
  ds_read_b64_tr_b16 v[44:45], v164 offset:37984
  v_mfma_f32_16x16x32_bf16 v[200:203], v[124:127], v[96:99], v[200:203]
  v_mfma_f32_16x16x32_bf16 v[204:207], v[112:115], v[96:99], v[204:207]
  ds_read_b64_tr_b16 v[46:47], v164 offset:40544
  v_mfma_f32_16x16x32_bf16 v[204:207], v[100:103], v[92:95], v[204:207]
  v_mfma_f32_16x16x32_bf16 v[208:211], v[116:119], v[68:71], v[208:211]
  ds_read_b128 v[12:15], v160 offset:45056
  v_mfma_f32_16x16x32_bf16 v[208:211], v[128:131], v[72:75], v[208:211]
  ds_read_b64_tr_b16 v[48:49], v164 offset:38016
  v_mfma_f32_16x16x32_bf16 v[212:215], v[128:131], v[76:79], v[212:215]
  v_mfma_f32_16x16x32_bf16 v[212:215], v[116:119], v[72:75], v[212:215]
  ds_read_b64_tr_b16 v[50:51], v164 offset:40576
  v_mfma_f32_16x16x32_bf16 v[212:215], v[104:107], v[68:71], v[212:215]
  v_mfma_f32_16x16x32_bf16 v[216:219], v[104:107], v[72:75], v[216:219]
  ds_read_b128 v[16:19], v160 offset:49152
  v_mfma_f32_16x16x32_bf16 v[216:219], v[116:119], v[76:79], v[216:219]
  v_mfma_f32_16x16x32_bf16 v[216:219], v[128:131], v[80:83], v[216:219]
  ds_read_b64_tr_b16 v[52:53], v164 offset:37952
  v_mfma_f32_16x16x32_bf16 v[220:223], v[128:131], v[84:87], v[220:223]
  v_mfma_f32_16x16x32_bf16 v[220:223], v[116:119], v[80:83], v[220:223]
  ds_read_b64_tr_b16 v[54:55], v164 offset:40512
  v_mfma_f32_16x16x32_bf16 v[220:223], v[104:107], v[76:79], v[220:223]
  v_mfma_f32_16x16x32_bf16 v[224:227], v[104:107], v[80:83], v[224:227]
  ds_read_b128 v[20:23], v160 offset:53248
  v_mfma_f32_16x16x32_bf16 v[224:227], v[116:119], v[84:87], v[224:227]
  v_mfma_f32_16x16x32_bf16 v[224:227], v[128:131], v[88:91], v[224:227]
  ds_read_b64_tr_b16 v[56:57], v164 offset:43104
  v_mfma_f32_16x16x32_bf16 v[228:231], v[128:131], v[92:95], v[228:231]
  ds_read_b64_tr_b16 v[58:59], v164 offset:45664
  v_mfma_f32_16x16x32_bf16 v[228:231], v[116:119], v[88:91], v[228:231]
  v_mfma_f32_16x16x32_bf16 v[228:231], v[104:107], v[84:87], v[228:231]
  ds_read_b128 v[24:27], v160 offset:57344
  v_mfma_f32_16x16x32_bf16 v[232:235], v[104:107], v[88:91], v[232:235]
  v_mfma_f32_16x16x32_bf16 v[232:235], v[116:119], v[92:95], v[232:235]
  ds_read_b64_tr_b16 v[60:61], v164 offset:43136
  v_mfma_f32_16x16x32_bf16 v[232:235], v[128:131], v[96:99], v[232:235]
  v_mfma_f32_16x16x32_bf16 v[236:239], v[116:119], v[96:99], v[236:239]
  ds_read_b64_tr_b16 v[62:63], v164 offset:45696
  v_mfma_f32_16x16x32_bf16 v[236:239], v[104:107], v[92:95], v[236:239]
  v_mfma_f32_16x16x32_bf16 v[240:243], v[108:111], v[80:83], v[240:243]
  ds_read_b128 v[28:31], v160 offset:61440
  v_mfma_f32_16x16x32_bf16 v[240:243], v[120:123], v[84:87], v[240:243]
  v_mfma_f32_16x16x32_bf16 v[240:243], v[132:135], v[88:91], v[240:243]
  ds_read_b64_tr_b16 v[64:65], v164 offset:43072
  v_mfma_f32_16x16x32_bf16 v[244:247], v[132:135], v[92:95], v[244:247]
  ds_read_b64_tr_b16 v[66:67], v164 offset:45632
  v_mfma_f32_16x16x32_bf16 v[244:247], v[120:123], v[88:91], v[244:247]
  v_mfma_f32_16x16x32_bf16 v[244:247], v[108:111], v[84:87], v[244:247]
  v_mfma_f32_16x16x32_bf16 v[248:251], v[108:111], v[88:91], v[248:251]
  v_mfma_f32_16x16x32_bf16 v[248:251], v[120:123], v[92:95], v[248:251]
  v_mfma_f32_16x16x32_bf16 v[248:251], v[132:135], v[96:99], v[248:251]
  v_mfma_f32_16x16x32_bf16 v[252:255], v[120:123], v[96:99], v[252:255]
  v_mfma_f32_16x16x32_bf16 v[252:255], v[108:111], v[92:95], v[252:255]
  s_waitcnt lgkmcnt(0)
  s_barrier
  v_mfma_f32_16x16x32_bf16 v[176:179], v[44:47], v[0:3], v[176:179]
  v_mfma_f32_16x16x32_bf16 v[176:179], v[56:59], v[4:7], v[176:179]
  ds_read_b64_tr_b16 v[100:101], v164 offset:49248
  v_mfma_f32_16x16x32_bf16 v[180:183], v[56:59], v[8:11], v[180:183]
  v_mfma_f32_16x16x32_bf16 v[180:183], v[44:47], v[4:7], v[180:183]
  ds_read_b64_tr_b16 v[102:103], v164 offset:51808
  v_mfma_f32_16x16x32_bf16 v[180:183], v[32:35], v[0:3], v[180:183]
  v_mfma_f32_16x16x32_bf16 v[184:187], v[32:35], v[4:7], v[184:187]
  ds_read_b128 v[68:71], v161 offset:32768
  v_mfma_f32_16x16x32_bf16 v[184:187], v[44:47], v[8:11], v[184:187]
  v_mfma_f32_16x16x32_bf16 v[184:187], v[56:59], v[12:15], v[184:187]
  ds_read_b64_tr_b16 v[104:105], v164 offset:49280
  v_mfma_f32_16x16x32_bf16 v[188:191], v[56:59], v[16:19], v[188:191]
  v_mfma_f32_16x16x32_bf16 v[188:191], v[44:47], v[12:15], v[188:191]
  ds_read_b64_tr_b16 v[106:107], v164 offset:51840
  v_mfma_f32_16x16x32_bf16 v[188:191], v[32:35], v[8:11], v[188:191]
  v_mfma_f32_16x16x32_bf16 v[192:195], v[32:35], v[12:15], v[192:195]
  ds_read_b128 v[72:75], v161 offset:36864
  v_mfma_f32_16x16x32_bf16 v[192:195], v[44:47], v[16:19], v[192:195]
  ds_read_b64_tr_b16 v[108:109], v164 offset:49216
  v_mfma_f32_16x16x32_bf16 v[192:195], v[56:59], v[20:23], v[192:195]
  v_mfma_f32_16x16x32_bf16 v[196:199], v[56:59], v[24:27], v[196:199]
  ds_read_b64_tr_b16 v[110:111], v164 offset:51776
  v_mfma_f32_16x16x32_bf16 v[196:199], v[44:47], v[20:23], v[196:199]
  v_mfma_f32_16x16x32_bf16 v[196:199], v[32:35], v[16:19], v[196:199]
  ds_read_b128 v[76:79], v161 offset:40960
  v_mfma_f32_16x16x32_bf16 v[200:203], v[32:35], v[20:23], v[200:203]
  v_mfma_f32_16x16x32_bf16 v[200:203], v[44:47], v[24:27], v[200:203]
  ds_read_b64_tr_b16 v[112:113], v164 offset:54368
  v_mfma_f32_16x16x32_bf16 v[200:203], v[56:59], v[28:31], v[200:203]
  v_mfma_f32_16x16x32_bf16 v[204:207], v[44:47], v[28:31], v[204:207]
  ds_read_b64_tr_b16 v[114:115], v164 offset:56928
  v_mfma_f32_16x16x32_bf16 v[204:207], v[32:35], v[24:27], v[204:207]
  v_mfma_f32_16x16x32_bf16 v[208:211], v[48:51], v[0:3], v[208:211]
  ds_read_b128 v[80:83], v161 offset:45056
  v_mfma_f32_16x16x32_bf16 v[208:211], v[60:63], v[4:7], v[208:211]
  ds_read_b64_tr_b16 v[116:117], v164 offset:54400
  v_mfma_f32_16x16x32_bf16 v[212:215], v[60:63], v[8:11], v[212:215]
  v_mfma_f32_16x16x32_bf16 v[212:215], v[48:51], v[4:7], v[212:215]
  ds_read_b64_tr_b16 v[118:119], v164 offset:56960
  v_mfma_f32_16x16x32_bf16 v[212:215], v[36:39], v[0:3], v[212:215]
  v_mfma_f32_16x16x32_bf16 v[216:219], v[36:39], v[4:7], v[216:219]
  ds_read_b128 v[84:87], v161 offset:49152
  v_mfma_f32_16x16x32_bf16 v[216:219], v[48:51], v[8:11], v[216:219]
  v_mfma_f32_16x16x32_bf16 v[216:219], v[60:63], v[12:15], v[216:219]
  ds_read_b64_tr_b16 v[120:121], v164 offset:54336
  v_mfma_f32_16x16x32_bf16 v[220:223], v[60:63], v[16:19], v[220:223]
  v_mfma_f32_16x16x32_bf16 v[220:223], v[48:51], v[12:15], v[220:223]
  ds_read_b64_tr_b16 v[122:123], v164 offset:56896
  v_mfma_f32_16x16x32_bf16 v[220:223], v[36:39], v[8:11], v[220:223]
  v_mfma_f32_16x16x32_bf16 v[224:227], v[36:39], v[12:15], v[224:227]
  ds_read_b128 v[88:91], v161 offset:53248
  v_mfma_f32_16x16x32_bf16 v[224:227], v[48:51], v[16:19], v[224:227]
  v_mfma_f32_16x16x32_bf16 v[224:227], v[60:63], v[20:23], v[224:227]
  ds_read_b64_tr_b16 v[124:125], v164 offset:59488
  v_mfma_f32_16x16x32_bf16 v[228:231], v[60:63], v[24:27], v[228:231]
  ds_read_b64_tr_b16 v[126:127], v164 offset:62048
  v_mfma_f32_16x16x32_bf16 v[228:231], v[48:51], v[20:23], v[228:231]
  v_mfma_f32_16x16x32_bf16 v[228:231], v[36:39], v[16:19], v[228:231]
  ds_read_b128 v[92:95], v161 offset:57344
  v_mfma_f32_16x16x32_bf16 v[232:235], v[36:39], v[20:23], v[232:235]
  v_mfma_f32_16x16x32_bf16 v[232:235], v[48:51], v[24:27], v[232:235]
  ds_read_b64_tr_b16 v[128:129], v164 offset:59520
  v_mfma_f32_16x16x32_bf16 v[232:235], v[60:63], v[28:31], v[232:235]
  v_mfma_f32_16x16x32_bf16 v[236:239], v[48:51], v[28:31], v[236:239]
  ds_read_b64_tr_b16 v[130:131], v164 offset:62080
  v_mfma_f32_16x16x32_bf16 v[236:239], v[36:39], v[24:27], v[236:239]
  v_mfma_f32_16x16x32_bf16 v[240:243], v[40:43], v[12:15], v[240:243]
  ds_read_b128 v[96:99], v161 offset:61440
  v_mfma_f32_16x16x32_bf16 v[240:243], v[52:55], v[16:19], v[240:243]
  v_mfma_f32_16x16x32_bf16 v[240:243], v[64:67], v[20:23], v[240:243]
  ds_read_b64_tr_b16 v[132:133], v164 offset:59456
  v_mfma_f32_16x16x32_bf16 v[244:247], v[64:67], v[24:27], v[244:247]
  ds_read_b64_tr_b16 v[134:135], v164 offset:62016
  v_mfma_f32_16x16x32_bf16 v[244:247], v[52:55], v[20:23], v[244:247]
  v_mfma_f32_16x16x32_bf16 v[244:247], v[40:43], v[16:19], v[244:247]
  v_mfma_f32_16x16x32_bf16 v[248:251], v[40:43], v[20:23], v[248:251]
  v_mfma_f32_16x16x32_bf16 v[248:251], v[52:55], v[24:27], v[248:251]
  v_mfma_f32_16x16x32_bf16 v[248:251], v[64:67], v[28:31], v[248:251]
  v_mfma_f32_16x16x32_bf16 v[252:255], v[52:55], v[28:31], v[252:255]
  v_mfma_f32_16x16x32_bf16 v[252:255], v[40:43], v[24:27], v[252:255]
  s_waitcnt lgkmcnt(0)
  s_barrier
  v_mfma_f32_16x16x32_bf16 v[176:179], v[112:115], v[68:71], v[176:179]
  v_mfma_f32_16x16x32_bf16 v[176:179], v[124:127], v[72:75], v[176:179]
  ds_read_b64_tr_b16 v[32:33], v164 offset:96
  v_mfma_f32_16x16x32_bf16 v[180:183], v[124:127], v[76:79], v[180:183]
  v_mfma_f32_16x16x32_bf16 v[180:183], v[112:115], v[72:75], v[180:183]
  ds_read_b64_tr_b16 v[34:35], v164 offset:2656
  v_mfma_f32_16x16x32_bf16 v[180:183], v[100:103], v[68:71], v[180:183]
  v_mfma_f32_16x16x32_bf16 v[184:187], v[100:103], v[72:75], v[184:187]
  ds_read_b128 v[0:3], v162 offset:0
  v_mfma_f32_16x16x32_bf16 v[184:187], v[112:115], v[76:79], v[184:187]
  v_mfma_f32_16x16x32_bf16 v[184:187], v[124:127], v[80:83], v[184:187]
  ds_read_b64_tr_b16 v[36:37], v164 offset:128
  v_mfma_f32_16x16x32_bf16 v[188:191], v[124:127], v[84:87], v[188:191]
  v_mfma_f32_16x16x32_bf16 v[188:191], v[112:115], v[80:83], v[188:191]
  ds_read_b64_tr_b16 v[38:39], v164 offset:2688
  v_mfma_f32_16x16x32_bf16 v[188:191], v[100:103], v[76:79], v[188:191]
  v_mfma_f32_16x16x32_bf16 v[192:195], v[100:103], v[80:83], v[192:195]
  ds_read_b128 v[4:7], v162 offset:4096
  v_mfma_f32_16x16x32_bf16 v[192:195], v[112:115], v[84:87], v[192:195]
  ds_read_b64_tr_b16 v[40:41], v164 offset:64
  v_mfma_f32_16x16x32_bf16 v[192:195], v[124:127], v[88:91], v[192:195]
  v_mfma_f32_16x16x32_bf16 v[196:199], v[124:127], v[92:95], v[196:199]
  ds_read_b64_tr_b16 v[42:43], v164 offset:2624
  v_mfma_f32_16x16x32_bf16 v[196:199], v[112:115], v[88:91], v[196:199]
  v_mfma_f32_16x16x32_bf16 v[196:199], v[100:103], v[84:87], v[196:199]
  ds_read_b128 v[8:11], v162 offset:8192
  v_mfma_f32_16x16x32_bf16 v[200:203], v[100:103], v[88:91], v[200:203]
  v_mfma_f32_16x16x32_bf16 v[200:203], v[112:115], v[92:95], v[200:203]
  ds_read_b64_tr_b16 v[44:45], v164 offset:5216
  v_mfma_f32_16x16x32_bf16 v[200:203], v[124:127], v[96:99], v[200:203]
  v_mfma_f32_16x16x32_bf16 v[204:207], v[112:115], v[96:99], v[204:207]
  ds_read_b64_tr_b16 v[46:47], v164 offset:7776
  v_mfma_f32_16x16x32_bf16 v[204:207], v[100:103], v[92:95], v[204:207]
  v_mfma_f32_16x16x32_bf16 v[208:211], v[116:119], v[68:71], v[208:211]
  ds_read_b128 v[12:15], v162 offset:12288
  v_mfma_f32_16x16x32_bf16 v[208:211], v[128:131], v[72:75], v[208:211]
  ds_read_b64_tr_b16 v[48:49], v164 offset:5248
  v_mfma_f32_16x16x32_bf16 v[212:215], v[128:131], v[76:79], v[212:215]
  v_mfma_f32_16x16x32_bf16 v[212:215], v[116:119], v[72:75], v[212:215]
  ds_read_b64_tr_b16 v[50:51], v164 offset:7808
  v_mfma_f32_16x16x32_bf16 v[212:215], v[104:107], v[68:71], v[212:215]
  v_mfma_f32_16x16x32_bf16 v[216:219], v[104:107], v[72:75], v[216:219]
  ds_read_b128 v[16:19], v162 offset:16384
  v_mfma_f32_16x16x32_bf16 v[216:219], v[116:119], v[76:79], v[216:219]
  v_mfma_f32_16x16x32_bf16 v[216:219], v[128:131], v[80:83], v[216:219]
  ds_read_b64_tr_b16 v[52:53], v164 offset:5184
  v_mfma_f32_16x16x32_bf16 v[220:223], v[128:131], v[84:87], v[220:223]
  v_mfma_f32_16x16x32_bf16 v[220:223], v[116:119], v[80:83], v[220:223]
  ds_read_b64_tr_b16 v[54:55], v164 offset:7744
  v_mfma_f32_16x16x32_bf16 v[220:223], v[104:107], v[76:79], v[220:223]
  v_mfma_f32_16x16x32_bf16 v[224:227], v[104:107], v[80:83], v[224:227]
  ds_read_b128 v[20:23], v162 offset:20480
  v_mfma_f32_16x16x32_bf16 v[224:227], v[116:119], v[84:87], v[224:227]
  v_mfma_f32_16x16x32_bf16 v[224:227], v[128:131], v[88:91], v[224:227]
  ds_read_b64_tr_b16 v[56:57], v164 offset:10336
  v_mfma_f32_16x16x32_bf16 v[228:231], v[128:131], v[92:95], v[228:231]
  ds_read_b64_tr_b16 v[58:59], v164 offset:12896
  v_mfma_f32_16x16x32_bf16 v[228:231], v[116:119], v[88:91], v[228:231]
  v_mfma_f32_16x16x32_bf16 v[228:231], v[104:107], v[84:87], v[228:231]
  ds_read_b128 v[24:27], v162 offset:24576
  v_mfma_f32_16x16x32_bf16 v[232:235], v[104:107], v[88:91], v[232:235]
  v_mfma_f32_16x16x32_bf16 v[232:235], v[116:119], v[92:95], v[232:235]
  ds_read_b64_tr_b16 v[60:61], v164 offset:10368
  v_mfma_f32_16x16x32_bf16 v[232:235], v[128:131], v[96:99], v[232:235]
  v_mfma_f32_16x16x32_bf16 v[236:239], v[116:119], v[96:99], v[236:239]
  ds_read_b64_tr_b16 v[62:63], v164 offset:12928
  v_mfma_f32_16x16x32_bf16 v[236:239], v[104:107], v[92:95], v[236:239]
  v_mfma_f32_16x16x32_bf16 v[240:243], v[108:111], v[80:83], v[240:243]
  ds_read_b128 v[28:31], v162 offset:28672
  v_mfma_f32_16x16x32_bf16 v[240:243], v[120:123], v[84:87], v[240:243]
  v_mfma_f32_16x16x32_bf16 v[240:243], v[132:135], v[88:91], v[240:243]
  ds_read_b64_tr_b16 v[64:65], v164 offset:10304
  v_mfma_f32_16x16x32_bf16 v[244:247], v[132:135], v[92:95], v[244:247]
  ds_read_b64_tr_b16 v[66:67], v164 offset:12864
  v_mfma_f32_16x16x32_bf16 v[244:247], v[120:123], v[88:91], v[244:247]
  v_mfma_f32_16x16x32_bf16 v[244:247], v[108:111], v[84:87], v[244:247]
  v_mfma_f32_16x16x32_bf16 v[248:251], v[108:111], v[88:91], v[248:251]
  v_mfma_f32_16x16x32_bf16 v[248:251], v[120:123], v[92:95], v[248:251]
  v_mfma_f32_16x16x32_bf16 v[248:251], v[132:135], v[96:99], v[248:251]
  v_mfma_f32_16x16x32_bf16 v[252:255], v[120:123], v[96:99], v[252:255]
  v_mfma_f32_16x16x32_bf16 v[252:255], v[108:111], v[92:95], v[252:255]
  s_waitcnt lgkmcnt(0)
  s_barrier
  v_mfma_f32_16x16x32_bf16 v[176:179], v[44:47], v[0:3], v[176:179]
  v_mfma_f32_16x16x32_bf16 v[176:179], v[56:59], v[4:7], v[176:179]
  ds_read_b64_tr_b16 v[100:101], v164 offset:16480
  v_mfma_f32_16x16x32_bf16 v[180:183], v[56:59], v[8:11], v[180:183]
  v_mfma_f32_16x16x32_bf16 v[180:183], v[44:47], v[4:7], v[180:183]
  ds_read_b64_tr_b16 v[102:103], v164 offset:19040
  v_mfma_f32_16x16x32_bf16 v[180:183], v[32:35], v[0:3], v[180:183]
  v_mfma_f32_16x16x32_bf16 v[184:187], v[32:35], v[4:7], v[184:187]
  ds_read_b128 v[68:71], v163 offset:0
  v_mfma_f32_16x16x32_bf16 v[184:187], v[44:47], v[8:11], v[184:187]
  v_mfma_f32_16x16x32_bf16 v[184:187], v[56:59], v[12:15], v[184:187]
  ds_read_b64_tr_b16 v[104:105], v164 offset:16512
  v_mfma_f32_16x16x32_bf16 v[188:191], v[56:59], v[16:19], v[188:191]
  v_mfma_f32_16x16x32_bf16 v[188:191], v[44:47], v[12:15], v[188:191]
  ds_read_b64_tr_b16 v[106:107], v164 offset:19072
  v_mfma_f32_16x16x32_bf16 v[188:191], v[32:35], v[8:11], v[188:191]
  v_mfma_f32_16x16x32_bf16 v[192:195], v[32:35], v[12:15], v[192:195]
  ds_read_b128 v[72:75], v163 offset:4096
  v_mfma_f32_16x16x32_bf16 v[192:195], v[44:47], v[16:19], v[192:195]
  ds_read_b64_tr_b16 v[108:109], v164 offset:16448
  v_mfma_f32_16x16x32_bf16 v[192:195], v[56:59], v[20:23], v[192:195]
  v_mfma_f32_16x16x32_bf16 v[196:199], v[56:59], v[24:27], v[196:199]
  ds_read_b64_tr_b16 v[110:111], v164 offset:19008
  v_mfma_f32_16x16x32_bf16 v[196:199], v[44:47], v[20:23], v[196:199]
  v_mfma_f32_16x16x32_bf16 v[196:199], v[32:35], v[16:19], v[196:199]
  ds_read_b128 v[76:79], v163 offset:8192
  v_mfma_f32_16x16x32_bf16 v[200:203], v[32:35], v[20:23], v[200:203]
  v_mfma_f32_16x16x32_bf16 v[200:203], v[44:47], v[24:27], v[200:203]
  ds_read_b64_tr_b16 v[112:113], v164 offset:21600
  v_mfma_f32_16x16x32_bf16 v[200:203], v[56:59], v[28:31], v[200:203]
  v_mfma_f32_16x16x32_bf16 v[204:207], v[44:47], v[28:31], v[204:207]
  ds_read_b64_tr_b16 v[114:115], v164 offset:24160
  v_mfma_f32_16x16x32_bf16 v[204:207], v[32:35], v[24:27], v[204:207]
  v_mfma_f32_16x16x32_bf16 v[208:211], v[48:51], v[0:3], v[208:211]
  ds_read_b128 v[80:83], v163 offset:12288
  v_mfma_f32_16x16x32_bf16 v[208:211], v[60:63], v[4:7], v[208:211]
  ds_read_b64_tr_b16 v[116:117], v164 offset:21632
  v_mfma_f32_16x16x32_bf16 v[212:215], v[60:63], v[8:11], v[212:215]
  v_mfma_f32_16x16x32_bf16 v[212:215], v[48:51], v[4:7], v[212:215]
  ds_read_b64_tr_b16 v[118:119], v164 offset:24192
  v_mfma_f32_16x16x32_bf16 v[212:215], v[36:39], v[0:3], v[212:215]
  v_mfma_f32_16x16x32_bf16 v[216:219], v[36:39], v[4:7], v[216:219]
  ds_read_b128 v[84:87], v163 offset:16384
  v_mfma_f32_16x16x32_bf16 v[216:219], v[48:51], v[8:11], v[216:219]
  v_mfma_f32_16x16x32_bf16 v[216:219], v[60:63], v[12:15], v[216:219]
  ds_read_b64_tr_b16 v[120:121], v164 offset:21568
  v_mfma_f32_16x16x32_bf16 v[220:223], v[60:63], v[16:19], v[220:223]
  v_mfma_f32_16x16x32_bf16 v[220:223], v[48:51], v[12:15], v[220:223]
  ds_read_b64_tr_b16 v[122:123], v164 offset:24128
  v_mfma_f32_16x16x32_bf16 v[220:223], v[36:39], v[8:11], v[220:223]
  v_mfma_f32_16x16x32_bf16 v[224:227], v[36:39], v[12:15], v[224:227]
  ds_read_b128 v[88:91], v163 offset:20480
  v_mfma_f32_16x16x32_bf16 v[224:227], v[48:51], v[16:19], v[224:227]
  v_mfma_f32_16x16x32_bf16 v[224:227], v[60:63], v[20:23], v[224:227]
  ds_read_b64_tr_b16 v[124:125], v164 offset:26720
  v_mfma_f32_16x16x32_bf16 v[228:231], v[60:63], v[24:27], v[228:231]
  ds_read_b64_tr_b16 v[126:127], v164 offset:29280
  v_mfma_f32_16x16x32_bf16 v[228:231], v[48:51], v[20:23], v[228:231]
  v_mfma_f32_16x16x32_bf16 v[228:231], v[36:39], v[16:19], v[228:231]
  ds_read_b128 v[92:95], v163 offset:24576
  v_mfma_f32_16x16x32_bf16 v[232:235], v[36:39], v[20:23], v[232:235]
  v_mfma_f32_16x16x32_bf16 v[232:235], v[48:51], v[24:27], v[232:235]
  ds_read_b64_tr_b16 v[128:129], v164 offset:26752
  v_mfma_f32_16x16x32_bf16 v[232:235], v[60:63], v[28:31], v[232:235]
  v_mfma_f32_16x16x32_bf16 v[236:239], v[48:51], v[28:31], v[236:239]
  ds_read_b64_tr_b16 v[130:131], v164 offset:29312
  v_mfma_f32_16x16x32_bf16 v[236:239], v[36:39], v[24:27], v[236:239]
  v_mfma_f32_16x16x32_bf16 v[240:243], v[40:43], v[12:15], v[240:243]
  ds_read_b128 v[96:99], v163 offset:28672
  v_mfma_f32_16x16x32_bf16 v[240:243], v[52:55], v[16:19], v[240:243]
  v_mfma_f32_16x16x32_bf16 v[240:243], v[64:67], v[20:23], v[240:243]
  ds_read_b64_tr_b16 v[132:133], v164 offset:26688
  v_mfma_f32_16x16x32_bf16 v[244:247], v[64:67], v[24:27], v[244:247]
  ds_read_b64_tr_b16 v[134:135], v164 offset:29248
  v_mfma_f32_16x16x32_bf16 v[244:247], v[52:55], v[20:23], v[244:247]
  v_mfma_f32_16x16x32_bf16 v[244:247], v[40:43], v[16:19], v[244:247]
  v_mfma_f32_16x16x32_bf16 v[248:251], v[40:43], v[20:23], v[248:251]
  v_mfma_f32_16x16x32_bf16 v[248:251], v[52:55], v[24:27], v[248:251]
  v_mfma_f32_16x16x32_bf16 v[248:251], v[64:67], v[28:31], v[248:251]
  v_mfma_f32_16x16x32_bf16 v[252:255], v[52:55], v[28:31], v[252:255]
  v_mfma_f32_16x16x32_bf16 v[252:255], v[40:43], v[24:27], v[252:255]
  s_waitcnt lgkmcnt(0)
  s_barrier
  v_mfma_f32_16x16x32_bf16 v[176:179], v[112:115], v[68:71], v[176:179]
  v_mfma_f32_16x16x32_bf16 v[176:179], v[124:127], v[72:75], v[176:179]
  ds_read_b64_tr_b16 v[32:33], v164 offset:32864
  v_mfma_f32_16x16x32_bf16 v[180:183], v[124:127], v[76:79], v[180:183]
  v_mfma_f32_16x16x32_bf16 v[180:183], v[112:115], v[72:75], v[180:183]
  ds_read_b64_tr_b16 v[34:35], v164 offset:35424
  v_mfma_f32_16x16x32_bf16 v[180:183], v[100:103], v[68:71], v[180:183]
  v_mfma_f32_16x16x32_bf16 v[184:187], v[100:103], v[72:75], v[184:187]
  ds_read_b128 v[0:3], v160 offset:0
  v_mfma_f32_16x16x32_bf16 v[184:187], v[112:115], v[76:79], v[184:187]
  v_mfma_f32_16x16x32_bf16 v[184:187], v[124:127], v[80:83], v[184:187]
  ds_read_b64_tr_b16 v[36:37], v164 offset:32896
  v_mfma_f32_16x16x32_bf16 v[188:191], v[124:127], v[84:87], v[188:191]
  v_mfma_f32_16x16x32_bf16 v[188:191], v[112:115], v[80:83], v[188:191]
  ds_read_b64_tr_b16 v[38:39], v164 offset:35456
  v_mfma_f32_16x16x32_bf16 v[188:191], v[100:103], v[76:79], v[188:191]
  v_mfma_f32_16x16x32_bf16 v[192:195], v[100:103], v[80:83], v[192:195]
  ds_read_b128 v[4:7], v160 offset:4096
  v_mfma_f32_16x16x32_bf16 v[192:195], v[112:115], v[84:87], v[192:195]
  ds_read_b64_tr_b16 v[40:41], v164 offset:32832
  v_mfma_f32_16x16x32_bf16 v[192:195], v[124:127], v[88:91], v[192:195]
  v_mfma_f32_16x16x32_bf16 v[196:199], v[124:127], v[92:95], v[196:199]
  ds_read_b64_tr_b16 v[42:43], v164 offset:35392
  v_mfma_f32_16x16x32_bf16 v[196:199], v[112:115], v[88:91], v[196:199]
  v_mfma_f32_16x16x32_bf16 v[196:199], v[100:103], v[84:87], v[196:199]
  ds_read_b128 v[8:11], v160 offset:8192
  v_mfma_f32_16x16x32_bf16 v[200:203], v[100:103], v[88:91], v[200:203]
  v_mfma_f32_16x16x32_bf16 v[200:203], v[112:115], v[92:95], v[200:203]
  ds_read_b64_tr_b16 v[44:45], v164 offset:37984
  v_mfma_f32_16x16x32_bf16 v[200:203], v[124:127], v[96:99], v[200:203]
  v_mfma_f32_16x16x32_bf16 v[204:207], v[112:115], v[96:99], v[204:207]
  ds_read_b64_tr_b16 v[46:47], v164 offset:40544
  v_mfma_f32_16x16x32_bf16 v[204:207], v[100:103], v[92:95], v[204:207]
  v_mfma_f32_16x16x32_bf16 v[208:211], v[116:119], v[68:71], v[208:211]
  ds_read_b128 v[12:15], v160 offset:12288
  v_mfma_f32_16x16x32_bf16 v[208:211], v[128:131], v[72:75], v[208:211]
  ds_read_b64_tr_b16 v[48:49], v164 offset:38016
  v_mfma_f32_16x16x32_bf16 v[212:215], v[128:131], v[76:79], v[212:215]
  v_mfma_f32_16x16x32_bf16 v[212:215], v[116:119], v[72:75], v[212:215]
  ds_read_b64_tr_b16 v[50:51], v164 offset:40576
  v_mfma_f32_16x16x32_bf16 v[212:215], v[104:107], v[68:71], v[212:215]
  v_mfma_f32_16x16x32_bf16 v[216:219], v[104:107], v[72:75], v[216:219]
  ds_read_b128 v[16:19], v160 offset:16384
  v_mfma_f32_16x16x32_bf16 v[216:219], v[116:119], v[76:79], v[216:219]
  v_mfma_f32_16x16x32_bf16 v[216:219], v[128:131], v[80:83], v[216:219]
  ds_read_b64_tr_b16 v[52:53], v164 offset:37952
  v_mfma_f32_16x16x32_bf16 v[220:223], v[128:131], v[84:87], v[220:223]
  v_mfma_f32_16x16x32_bf16 v[220:223], v[116:119], v[80:83], v[220:223]
  ds_read_b64_tr_b16 v[54:55], v164 offset:40512
  v_mfma_f32_16x16x32_bf16 v[220:223], v[104:107], v[76:79], v[220:223]
  v_mfma_f32_16x16x32_bf16 v[224:227], v[104:107], v[80:83], v[224:227]
  ds_read_b128 v[20:23], v160 offset:20480
  v_mfma_f32_16x16x32_bf16 v[224:227], v[116:119], v[84:87], v[224:227]
  v_mfma_f32_16x16x32_bf16 v[224:227], v[128:131], v[88:91], v[224:227]
  ds_read_b64_tr_b16 v[56:57], v164 offset:43104
  v_mfma_f32_16x16x32_bf16 v[228:231], v[128:131], v[92:95], v[228:231]
  ds_read_b64_tr_b16 v[58:59], v164 offset:45664
  v_mfma_f32_16x16x32_bf16 v[228:231], v[116:119], v[88:91], v[228:231]
  v_mfma_f32_16x16x32_bf16 v[228:231], v[104:107], v[84:87], v[228:231]
  ds_read_b128 v[24:27], v160 offset:24576
  v_mfma_f32_16x16x32_bf16 v[232:235], v[104:107], v[88:91], v[232:235]
  v_mfma_f32_16x16x32_bf16 v[232:235], v[116:119], v[92:95], v[232:235]
  ds_read_b64_tr_b16 v[60:61], v164 offset:43136
  v_mfma_f32_16x16x32_bf16 v[232:235], v[128:131], v[96:99], v[232:235]
  v_mfma_f32_16x16x32_bf16 v[236:239], v[116:119], v[96:99], v[236:239]
  ds_read_b64_tr_b16 v[62:63], v164 offset:45696
  v_mfma_f32_16x16x32_bf16 v[236:239], v[104:107], v[92:95], v[236:239]
  v_mfma_f32_16x16x32_bf16 v[240:243], v[108:111], v[80:83], v[240:243]
  ds_read_b128 v[28:31], v160 offset:28672
  v_mfma_f32_16x16x32_bf16 v[240:243], v[120:123], v[84:87], v[240:243]
  v_mfma_f32_16x16x32_bf16 v[240:243], v[132:135], v[88:91], v[240:243]
  ds_read_b64_tr_b16 v[64:65], v164 offset:43072
  v_mfma_f32_16x16x32_bf16 v[244:247], v[132:135], v[92:95], v[244:247]
  ds_read_b64_tr_b16 v[66:67], v164 offset:45632
  v_mfma_f32_16x16x32_bf16 v[244:247], v[120:123], v[88:91], v[244:247]
  v_mfma_f32_16x16x32_bf16 v[244:247], v[108:111], v[84:87], v[244:247]
  v_mfma_f32_16x16x32_bf16 v[248:251], v[108:111], v[88:91], v[248:251]
  ds_write_b32 v167, v140
  v_mfma_f32_16x16x32_bf16 v[248:251], v[120:123], v[92:95], v[248:251]
  ds_write_b32 v167, v141 offset:320
  v_mfma_f32_16x16x32_bf16 v[248:251], v[132:135], v[96:99], v[248:251]
  v_mfma_f32_16x16x32_bf16 v[252:255], v[120:123], v[96:99], v[252:255]
  v_mfma_f32_16x16x32_bf16 v[252:255], v[108:111], v[92:95], v[252:255]
  s_waitcnt lgkmcnt(0)
L_pad_hi_3:
  s_cbranch_scc1 L_warm_hi
  s_barrier
  v_mfma_f32_16x16x32_bf16 v[176:179], v[44:47], v[0:3], v[176:179]
  v_mfma_f32_16x16x32_bf16 v[176:179], v[56:59], v[4:7], v[176:179]
  ds_read_b64_tr_b16 v[100:101], v164 offset:49248
  v_mfma_f32_16x16x32_bf16 v[180:183], v[56:59], v[8:11], v[180:183]
  v_mfma_f32_16x16x32_bf16 v[180:183], v[44:47], v[4:7], v[180:183]
  ds_read_b64_tr_b16 v[102:103], v164 offset:51808
  v_mfma_f32_16x16x32_bf16 v[180:183], v[32:35], v[0:3], v[180:183]
  v_mfma_f32_16x16x32_bf16 v[184:187], v[32:35], v[4:7], v[184:187]
  ds_read_b128 v[68:71], v161 offset:0
  v_mfma_f32_16x16x32_bf16 v[184:187], v[44:47], v[8:11], v[184:187]
  v_mfma_f32_16x16x32_bf16 v[184:187], v[56:59], v[12:15], v[184:187]
  ds_read_b64_tr_b16 v[104:105], v164 offset:49280
  v_mfma_f32_16x16x32_bf16 v[188:191], v[56:59], v[16:19], v[188:191]
  v_mfma_f32_16x16x32_bf16 v[188:191], v[44:47], v[12:15], v[188:191]
  ds_read_b64_tr_b16 v[106:107], v164 offset:51840
  v_mfma_f32_16x16x32_bf16 v[188:191], v[32:35], v[8:11], v[188:191]
  v_mfma_f32_16x16x32_bf16 v[192:195], v[32:35], v[12:15], v[192:195]
  ds_read_b128 v[72:75], v161 offset:4096
  v_mfma_f32_16x16x32_bf16 v[192:195], v[44:47], v[16:19], v[192:195]
  ds_read_b64_tr_b16 v[108:109], v164 offset:49216
  v_mfma_f32_16x16x32_bf16 v[192:195], v[56:59], v[20:23], v[192:195]
  v_mfma_f32_16x16x32_bf16 v[196:199], v[56:59], v[24:27], v[196:199]
  ds_read_b64_tr_b16 v[110:111], v164 offset:51776
  v_mfma_f32_16x16x32_bf16 v[196:199], v[44:47], v[20:23], v[196:199]
  v_mfma_f32_16x16x32_bf16 v[196:199], v[32:35], v[16:19], v[196:199]
  ds_read_b128 v[76:79], v161 offset:8192
  v_mfma_f32_16x16x32_bf16 v[200:203], v[32:35], v[20:23], v[200:203]
  v_mfma_f32_16x16x32_bf16 v[200:203], v[44:47], v[24:27], v[200:203]
  ds_read_b64_tr_b16 v[112:113], v164 offset:54368
  v_mfma_f32_16x16x32_bf16 v[200:203], v[56:59], v[28:31], v[200:203]
  v_mfma_f32_16x16x32_bf16 v[204:207], v[44:47], v[28:31], v[204:207]
  ds_read_b64_tr_b16 v[114:115], v164 offset:56928
  v_mfma_f32_16x16x32_bf16 v[204:207], v[32:35], v[24:27], v[204:207]
  v_mfma_f32_16x16x32_bf16 v[208:211], v[48:51], v[0:3], v[208:211]
  ds_read_b128 v[80:83], v161 offset:12288
  v_mfma_f32_16x16x32_bf16 v[208:211], v[60:63], v[4:7], v[208:211]
  ds_read_b64_tr_b16 v[116:117], v164 offset:54400
  v_mfma_f32_16x16x32_bf16 v[212:215], v[60:63], v[8:11], v[212:215]
  v_mfma_f32_16x16x32_bf16 v[212:215], v[48:51], v[4:7], v[212:215]
  ds_read_b64_tr_b16 v[118:119], v164 offset:56960
  v_mfma_f32_16x16x32_bf16 v[212:215], v[36:39], v[0:3], v[212:215]
  v_mfma_f32_16x16x32_bf16 v[216:219], v[36:39], v[4:7], v[216:219]
  ds_read_b128 v[84:87], v161 offset:16384
  v_mfma_f32_16x16x32_bf16 v[216:219], v[48:51], v[8:11], v[216:219]
  v_mfma_f32_16x16x32_bf16 v[216:219], v[60:63], v[12:15], v[216:219]
  ds_read_b64_tr_b16 v[120:121], v164 offset:54336
  v_mfma_f32_16x16x32_bf16 v[220:223], v[60:63], v[16:19], v[220:223]
  v_mfma_f32_16x16x32_bf16 v[220:223], v[48:51], v[12:15], v[220:223]
  ds_read_b64_tr_b16 v[122:123], v164 offset:56896
  v_mfma_f32_16x16x32_bf16 v[220:223], v[36:39], v[8:11], v[220:223]
  v_mfma_f32_16x16x32_bf16 v[224:227], v[36:39], v[12:15], v[224:227]
  ds_read_b128 v[88:91], v161 offset:20480
  v_mfma_f32_16x16x32_bf16 v[224:227], v[48:51], v[16:19], v[224:227]
  v_mfma_f32_16x16x32_bf16 v[224:227], v[60:63], v[20:23], v[224:227]
  ds_read_b64_tr_b16 v[124:125], v164 offset:59488
  v_mfma_f32_16x16x32_bf16 v[228:231], v[60:63], v[24:27], v[228:231]
  ds_read_b64_tr_b16 v[126:127], v164 offset:62048
  v_mfma_f32_16x16x32_bf16 v[228:231], v[48:51], v[20:23], v[228:231]
  v_mfma_f32_16x16x32_bf16 v[228:231], v[36:39], v[16:19], v[228:231]
  ds_read_b128 v[92:95], v161 offset:24576
  v_mfma_f32_16x16x32_bf16 v[232:235], v[36:39], v[20:23], v[232:235]
  v_mfma_f32_16x16x32_bf16 v[232:235], v[48:51], v[24:27], v[232:235]
  ds_read_b64_tr_b16 v[128:129], v164 offset:59520
  v_mfma_f32_16x16x32_bf16 v[232:235], v[60:63], v[28:31], v[232:235]
  v_mfma_f32_16x16x32_bf16 v[236:239], v[48:51], v[28:31], v[236:239]
  ds_read_b64_tr_b16 v[130:131], v164 offset:62080
  v_mfma_f32_16x16x32_bf16 v[236:239], v[36:39], v[24:27], v[236:239]
  v_mfma_f32_16x16x32_bf16 v[240:243], v[40:43], v[12:15], v[240:243]
  ds_read_b128 v[96:99], v161 offset:28672
  v_mfma_f32_16x16x32_bf16 v[240:243], v[52:55], v[16:19], v[240:243]
  v_mfma_f32_16x16x32_bf16 v[240:243], v[64:67], v[20:23], v[240:243]
  ds_read_b64_tr_b16 v[132:133], v164 offset:59456
  v_mfma_f32_16x16x32_bf16 v[244:247], v[64:67], v[24:27], v[244:247]
  ds_read_b64_tr_b16 v[134:135], v164 offset:62016
  v_mfma_f32_16x16x32_bf16 v[244:247], v[52:55], v[20:23], v[244:247]
  v_mfma_f32_16x16x32_bf16 v[244:247], v[40:43], v[16:19], v[244:247]
  v_mfma_f32_16x16x32_bf16 v[248:251], v[40:43], v[20:23], v[248:251]
  v_mfma_f32_16x16x32_bf16 v[248:251], v[52:55], v[24:27], v[248:251]
  v_mfma_f32_16x16x32_bf16 v[248:251], v[64:67], v[28:31], v[248:251]
  v_mfma_f32_16x16x32_bf16 v[252:255], v[52:55], v[28:31], v[252:255]
  v_mfma_f32_16x16x32_bf16 v[252:255], v[40:43], v[24:27], v[252:255]
  s_waitcnt lgkmcnt(0)
  s_barrier
  v_mfma_f32_16x16x32_bf16 v[176:179], v[112:115], v[68:71], v[176:179]
  v_mfma_f32_16x16x32_bf16 v[176:179], v[124:127], v[72:75], v[176:179]
  v_mfma_f32_16x16x32_bf16 v[180:183], v[124:127], v[76:79], v[180:183]
  v_mfma_f32_16x16x32_bf16 v[180:183], v[112:115], v[72:75], v[180:183]
  ds_read_b128 v[52:55], v166 offset:192
  v_mfma_f32_16x16x32_bf16 v[180:183], v[100:103], v[68:71], v[180:183]
  v_mfma_f32_16x16x32_bf16 v[184:187], v[100:103], v[72:75], v[184:187]
  v_mfma_f32_16x16x32_bf16 v[184:187], v[112:115], v[76:79], v[184:187]
  v_mfma_f32_16x16x32_bf16 v[184:187], v[124:127], v[80:83], v[184:187]
  ds_read_b128 v[136:139], v166 offset:512
  v_mfma_f32_16x16x32_bf16 v[188:191], v[124:127], v[84:87], v[188:191]
  v_mfma_f32_16x16x32_bf16 v[188:191], v[112:115], v[80:83], v[188:191]
  v_mfma_f32_16x16x32_bf16 v[188:191], v[100:103], v[76:79], v[188:191]
  v_mfma_f32_16x16x32_bf16 v[192:195], v[100:103], v[80:83], v[192:195]
  ds_read_b128 v[56:59], v166 offset:256
  v_mfma_f32_16x16x32_bf16 v[192:195], v[112:115], v[84:87], v[192:195]
  v_mfma_f32_16x16x32_bf16 v[192:195], v[124:127], v[88:91], v[192:195]
  v_mfma_f32_16x16x32_bf16 v[196:199], v[124:127], v[92:95], v[196:199]
  ds_read_b128 v[140:143], v166 offset:576
  v_mfma_f32_16x16x32_bf16 v[196:199], v[112:115], v[88:91], v[196:199]
  v_mfma_f32_16x16x32_bf16 v[196:199], v[100:103], v[84:87], v[196:199]
  v_mfma_f32_16x16x32_bf16 v[200:203], v[100:103], v[88:91], v[200:203]
  v_mfma_f32_16x16x32_bf16 v[200:203], v[112:115], v[92:95], v[200:203]
  ds_read_b128 v[60:63], v166 offset:128
  v_mfma_f32_16x16x32_bf16 v[200:203], v[124:127], v[96:99], v[200:203]
  v_mfma_f32_16x16x32_bf16 v[204:207], v[112:115], v[96:99], v[204:207]
  v_mfma_f32_16x16x32_bf16 v[204:207], v[100:103], v[92:95], v[204:207]
  v_mfma_f32_16x16x32_bf16 v[208:211], v[116:119], v[68:71], v[208:211]
  ds_read_b128 v[144:147], v166 offset:448
  v_mfma_f32_16x16x32_bf16 v[208:211], v[128:131], v[72:75], v[208:211]
  v_mfma_f32_16x16x32_bf16 v[212:215], v[128:131], v[76:79], v[212:215]
  v_mfma_f32_16x16x32_bf16 v[212:215], v[116:119], v[72:75], v[212:215]
  v_mfma_f32_16x16x32_bf16 v[212:215], v[104:107], v[68:71], v[212:215]
  v_mov_b32 v64, 0xbfb8aa3b
  v_mfma_f32_16x16x32_bf16 v[216:219], v[104:107], v[72:75], v[216:219]
  v_mfma_f32_16x16x32_bf16 v[216:219], v[116:119], v[76:79], v[216:219]
  v_mfma_f32_16x16x32_bf16 v[216:219], v[128:131], v[80:83], v[216:219]
  v_mov_b32 v65, 0xbfb8aa3b
  v_mfma_f32_16x16x32_bf16 v[220:223], v[128:131], v[84:87], v[220:223]
  v_mfma_f32_16x16x32_bf16 v[220:223], v[116:119], v[80:83], v[220:223]
  v_mfma_f32_16x16x32_bf16 v[220:223], v[104:107], v[76:79], v[220:223]
  v_mfma_f32_16x16x32_bf16 v[224:227], v[104:107], v[80:83], v[224:227]
  v_mfma_f32_16x16x32_bf16 v[224:227], v[116:119], v[84:87], v[224:227]
  v_mfma_f32_16x16x32_bf16 v[224:227], v[128:131], v[88:91], v[224:227]
  v_mfma_f32_16x16x32_bf16 v[228:231], v[128:131], v[92:95], v[228:231]
  v_mfma_f32_16x16x32_bf16 v[228:231], v[116:119], v[88:91], v[228:231]
  v_mfma_f32_16x16x32_bf16 v[228:231], v[104:107], v[84:87], v[228:231]
  v_mfma_f32_16x16x32_bf16 v[232:235], v[104:107], v[88:91], v[232:235]
  v_mfma_f32_16x16x32_bf16 v[232:235], v[116:119], v[92:95], v[232:235]
  v_mfma_f32_16x16x32_bf16 v[232:235], v[128:131], v[96:99], v[232:235]
  v_mfma_f32_16x16x32_bf16 v[236:239], v[116:119], v[96:99], v[236:239]
  v_mfma_f32_16x16x32_bf16 v[236:239], v[104:107], v[92:95], v[236:239]
  v_mfma_f32_16x16x32_bf16 v[240:243], v[108:111], v[80:83], v[240:243]
  v_mfma_f32_16x16x32_bf16 v[240:243], v[120:123], v[84:87], v[240:243]
  v_mfma_f32_16x16x32_bf16 v[240:243], v[132:135], v[88:91], v[240:243]
  v_mfma_f32_16x16x32_bf16 v[244:247], v[132:135], v[92:95], v[244:247]
  v_mfma_f32_16x16x32_bf16 v[244:247], v[120:123], v[88:91], v[244:247]
  v_mfma_f32_16x16x32_bf16 v[244:247], v[108:111], v[84:87], v[244:247]
  v_mfma_f32_16x16x32_bf16 v[248:251], v[108:111], v[88:91], v[248:251]
  v_mfma_f32_16x16x32_bf16 v[248:251], v[120:123], v[92:95], v[248:251]
  v_mfma_f32_16x16x32_bf16 v[248:251], v[132:135], v[96:99], v[248:251]
  v_mfma_f32_16x16x32_bf16 v[252:255], v[120:123], v[96:99], v[252:255]
  v_mfma_f32_16x16x32_bf16 v[252:255], v[108:111], v[92:95], v[252:255]
  s_waitcnt lgkmcnt(0)
  s_nop 0
  v_pk_fma_f32 v[0:1], v[176:177], v[52:53], v[136:137]
  v_pk_fma_f32 v[2:3], v[178:179], v[54:55], v[138:139]
  v_pk_fma_f32 v[4:5], v[208:209], v[56:57], v[140:141]
  v_pk_fma_f32 v[6:7], v[210:211], v[58:59], v[142:143]
  v_pk_fma_f32 v[8:9], v[192:193], v[52:53], v[136:137]
  v_pk_fma_f32 v[10:11], v[194:195], v[54:55], v[138:139]
  v_pk_fma_f32 v[12:13], v[224:225], v[56:57], v[140:141]
  v_pk_fma_f32 v[14:15], v[226:227], v[58:59], v[142:143]
  v_pk_fma_f32 v[16:17], v[240:241], v[60:61], v[144:145]
  v_pk_fma_f32 v[18:19], v[242:243], v[62:63], v[146:147]
  v_exp_f32 v20, v0
  v_exp_f32 v21, v1
  v_exp_f32 v22, v2
  v_exp_f32 v23, v3
  v_exp_f32 v24, v4
  v_exp_f32 v25, v5
  v_exp_f32 v26, v6
  v_exp_f32 v27, v7
  v_exp_f32 v28, v8
  v_exp_f32 v29, v9
  v_exp_f32 v30, v10
  v_exp_f32 v31, v11
  v_exp_f32 v32, v12
  v_exp_f32 v33, v13
  v_exp_f32 v34, v14
  v_exp_f32 v35, v15
  v_exp_f32 v36, v16
  v_exp_f32 v37, v17
  v_exp_f32 v38, v18
  v_exp_f32 v39, v19
  v_pk_fma_f32 v[20:21], v[20:21], v[64:65], v[64:65]
  v_pk_fma_f32 v[22:23], v[22:23], v[64:65], v[64:65]
  v_pk_fma_f32 v[24:25], v[24:25], v[64:65], v[64:65]
  v_pk_fma_f32 v[26:27], v[26:27], v[64:65], v[64:65]
  v_pk_fma_f32 v[28:29], v[28:29], v[64:65], v[64:65]
  v_pk_fma_f32 v[30:31], v[30:31], v[64:65], v[64:65]
  v_pk_fma_f32 v[32:33], v[32:33], v[64:65], v[64:65]
  v_pk_fma_f32 v[34:35], v[34:35], v[64:65], v[64:65]
  v_pk_fma_f32 v[36:37], v[36:37], v[64:65], v[64:65]
  v_pk_fma_f32 v[38:39], v[38:39], v[64:65], v[64:65]
  v_rcp_f32 v20, v20
  v_rcp_f32 v21, v21
  v_rcp_f32 v22, v22
  v_rcp_f32 v23, v23
  v_rcp_f32 v24, v24
  v_rcp_f32 v25, v25
  v_rcp_f32 v26, v26
  v_rcp_f32 v27, v27
  v_rcp_f32 v28, v28
  v_rcp_f32 v29, v29
  v_rcp_f32 v30, v30
  v_rcp_f32 v31, v31
  v_rcp_f32 v32, v32
  v_rcp_f32 v33, v33
  v_rcp_f32 v34, v34
  v_rcp_f32 v35, v35
  v_rcp_f32 v36, v36
  v_rcp_f32 v37, v37
  v_rcp_f32 v38, v38
  v_rcp_f32 v39, v39
  v_pk_mul_f32 v[0:1], v[0:1], v[20:21]
  v_pk_mul_f32 v[2:3], v[2:3], v[22:23]
  v_pk_mul_f32 v[4:5], v[4:5], v[24:25]
  v_pk_mul_f32 v[6:7], v[6:7], v[26:27]
  v_pk_mul_f32 v[8:9], v[8:9], v[28:29]
  v_pk_mul_f32 v[10:11], v[10:11], v[30:31]
  v_pk_mul_f32 v[12:13], v[12:13], v[32:33]
  v_pk_mul_f32 v[14:15], v[14:15], v[34:35]
  v_pk_mul_f32 v[16:17], v[16:17], v[36:37]
  v_pk_mul_f32 v[18:19], v[18:19], v[38:39]
  v_cvt_pk_bf16_f32 v40, v0, v1
  v_cvt_pk_bf16_f32 v41, v2, v3
  ds_write_b64 v165, v[40:41] offset:96
  v_cvt_pk_bf16_f32 v42, v4, v5
  v_cvt_pk_bf16_f32 v43, v6, v7
  ds_write_b64 v165, v[42:43] offset:128
  v_cvt_pk_bf16_f32 v44, v8, v9
  v_cvt_pk_bf16_f32 v45, v10, v11
  ds_write_b64 v165, v[44:45] offset:22624
  v_cvt_pk_bf16_f32 v46, v12, v13
  v_cvt_pk_bf16_f32 v47, v14, v15
  ds_write_b64 v165, v[46:47] offset:22656
  v_cvt_pk_bf16_f32 v48, v16, v17
  v_cvt_pk_bf16_f32 v49, v18, v19
  ds_write_b64 v165, v[48:49] offset:22592
  v_pk_fma_f32 v[0:1], v[180:181], v[52:53], v[136:137]
  v_pk_fma_f32 v[2:3], v[182:183], v[54:55], v[138:139]
  v_pk_fma_f32 v[4:5], v[212:213], v[56:57], v[140:141]
  v_pk_fma_f32 v[6:7], v[214:215], v[58:59], v[142:143]
  v_pk_fma_f32 v[8:9], v[196:197], v[52:53], v[136:137]
  v_pk_fma_f32 v[10:11], v[198:199], v[54:55], v[138:139]
  v_pk_fma_f32 v[12:13], v[228:229], v[56:57], v[140:141]
  v_pk_fma_f32 v[14:15], v[230:231], v[58:59], v[142:143]
  v_pk_fma_f32 v[16:17], v[244:245], v[60:61], v[144:145]
  v_pk_fma_f32 v[18:19], v[246:247], v[62:63], v[146:147]
  v_exp_f32 v20, v0
  v_exp_f32 v21, v1
  v_exp_f32 v22, v2
  v_exp_f32 v23, v3
  v_exp_f32 v24, v4
  v_exp_f32 v25, v5
  v_exp_f32 v26, v6
  v_exp_f32 v27, v7
  v_exp_f32 v28, v8
  v_exp_f32 v29, v9
  v_exp_f32 v30, v10
  v_exp_f32 v31, v11
  v_exp_f32 v32, v12
  v_exp_f32 v33, v13
  v_exp_f32 v34, v14
  v_exp_f32 v35, v15
  v_exp_f32 v36, v16
  v_exp_f32 v37, v17
  v_exp_f32 v38, v18
  v_exp_f32 v39, v19
  s_waitcnt lgkmcnt(0)
  s_barrier
  v_pk_fma_f32 v[20:21], v[20:21], v[64:65], v[64:65]
  v_pk_fma_f32 v[22:23], v[22:23], v[64:65], v[64:65]
  v_pk_fma_f32 v[24:25], v[24:25], v[64:65], v[64:65]
  v_pk_fma_f32 v[26:27], v[26:27], v[64:65], v[64:65]
  v_pk_fma_f32 v[28:29], v[28:29], v[64:65], v[64:65]
  v_pk_fma_f32 v[30:31], v[30:31], v[64:65], v[64:65]
  v_pk_fma_f32 v[32:33], v[32:33], v[64:65], v[64:65]
  v_pk_fma_f32 v[34:35], v[34:35], v[64:65], v[64:65]
  v_pk_fma_f32 v[36:37], v[36:37], v[64:65], v[64:65]
  v_pk_fma_f32 v[38:39], v[38:39], v[64:65], v[64:65]
  v_rcp_f32 v20, v20
  v_rcp_f32 v21, v21
  v_rcp_f32 v22, v22
  v_rcp_f32 v23, v23
  v_rcp_f32 v24, v24
  v_rcp_f32 v25, v25
  v_rcp_f32 v26, v26
  v_rcp_f32 v27, v27
  v_rcp_f32 v28, v28
  v_rcp_f32 v29, v29
  v_rcp_f32 v30, v30
  v_rcp_f32 v31, v31
  v_rcp_f32 v32, v32
  v_rcp_f32 v33, v33
  v_rcp_f32 v34, v34
  v_rcp_f32 v35, v35
  v_rcp_f32 v36, v36
  v_rcp_f32 v37, v37
  v_rcp_f32 v38, v38
  v_rcp_f32 v39, v39
  v_pk_mul_f32 v[0:1], v[0:1], v[20:21]
  v_pk_mul_f32 v[2:3], v[2:3], v[22:23]
  v_pk_mul_f32 v[4:5], v[4:5], v[24:25]
  v_pk_mul_f32 v[6:7], v[6:7], v[26:27]
  v_pk_mul_f32 v[8:9], v[8:9], v[28:29]
  v_pk_mul_f32 v[10:11], v[10:11], v[30:31]
  v_pk_mul_f32 v[12:13], v[12:13], v[32:33]
  v_pk_mul_f32 v[14:15], v[14:15], v[34:35]
  v_pk_mul_f32 v[16:17], v[16:17], v[36:37]
  v_pk_mul_f32 v[18:19], v[18:19], v[38:39]
  v_cvt_pk_bf16_f32 v40, v0, v1
  v_cvt_pk_bf16_f32 v41, v2, v3
  ds_write_b64 v165, v[40:41] offset:5728
  v_cvt_pk_bf16_f32 v42, v4, v5
  v_cvt_pk_bf16_f32 v43, v6, v7
  ds_write_b64 v165, v[42:43] offset:5760
  v_cvt_pk_bf16_f32 v44, v8, v9
  v_cvt_pk_bf16_f32 v45, v10, v11
  ds_write_b64 v165, v[44:45] offset:28256
  v_cvt_pk_bf16_f32 v46, v12, v13
  v_cvt_pk_bf16_f32 v47, v14, v15
  ds_write_b64 v165, v[46:47] offset:28288
  v_cvt_pk_bf16_f32 v48, v16, v17
  v_cvt_pk_bf16_f32 v49, v18, v19
  ds_write_b64 v165, v[48:49] offset:28224
  v_pk_fma_f32 v[0:1], v[184:185], v[52:53], v[136:137]
  v_pk_fma_f32 v[2:3], v[186:187], v[54:55], v[138:139]
  v_pk_fma_f32 v[4:5], v[216:217], v[56:57], v[140:141]
  v_pk_fma_f32 v[6:7], v[218:219], v[58:59], v[142:143]
  v_pk_fma_f32 v[8:9], v[200:201], v[52:53], v[136:137]
  v_pk_fma_f32 v[10:11], v[202:203], v[54:55], v[138:139]
  v_pk_fma_f32 v[12:13], v[232:233], v[56:57], v[140:141]
  v_pk_fma_f32 v[14:15], v[234:235], v[58:59], v[142:143]
  v_pk_fma_f32 v[16:17], v[248:249], v[60:61], v[144:145]
  v_pk_fma_f32 v[18:19], v[250:251], v[62:63], v[146:147]
  v_exp_f32 v20, v0
  v_exp_f32 v21, v1
  v_exp_f32 v22, v2
  v_exp_f32 v23, v3
  v_exp_f32 v24, v4
  v_exp_f32 v25, v5
  v_exp_f32 v26, v6
  v_exp_f32 v27, v7
  v_exp_f32 v28, v8
  v_exp_f32 v29, v9
  v_exp_f32 v30, v10
  v_exp_f32 v31, v11
  v_exp_f32 v32, v12
  v_exp_f32 v33, v13
  v_exp_f32 v34, v14
  v_exp_f32 v35, v15
  v_exp_f32 v36, v16
  v_exp_f32 v37, v17
  v_exp_f32 v38, v18
  v_exp_f32 v39, v19
  s_waitcnt lgkmcnt(0)
  s_barrier
  v_pk_fma_f32 v[20:21], v[20:21], v[64:65], v[64:65]
  v_pk_fma_f32 v[22:23], v[22:23], v[64:65], v[64:65]
  v_pk_fma_f32 v[24:25], v[24:25], v[64:65], v[64:65]
  v_pk_fma_f32 v[26:27], v[26:27], v[64:65], v[64:65]
  v_pk_fma_f32 v[28:29], v[28:29], v[64:65], v[64:65]
  v_pk_fma_f32 v[30:31], v[30:31], v[64:65], v[64:65]
  v_pk_fma_f32 v[32:33], v[32:33], v[64:65], v[64:65]
  v_pk_fma_f32 v[34:35], v[34:35], v[64:65], v[64:65]
  v_pk_fma_f32 v[36:37], v[36:37], v[64:65], v[64:65]
  v_pk_fma_f32 v[38:39], v[38:39], v[64:65], v[64:65]
  v_rcp_f32 v20, v20
  v_rcp_f32 v21, v21
  v_rcp_f32 v22, v22
  v_rcp_f32 v23, v23
  v_rcp_f32 v24, v24
  v_rcp_f32 v25, v25
  v_rcp_f32 v26, v26
  v_rcp_f32 v27, v27
  v_rcp_f32 v28, v28
  v_rcp_f32 v29, v29
  v_rcp_f32 v30, v30
  v_rcp_f32 v31, v31
  v_rcp_f32 v32, v32
  v_rcp_f32 v33, v33
  v_rcp_f32 v34, v34
  v_rcp_f32 v35, v35
  v_rcp_f32 v36, v36
  v_rcp_f32 v37, v37
  v_rcp_f32 v38, v38
  v_rcp_f32 v39, v39
  v_pk_mul_f32 v[0:1], v[0:1], v[20:21]
  v_pk_mul_f32 v[2:3], v[2:3], v[22:23]
  v_pk_mul_f32 v[4:5], v[4:5], v[24:25]
  v_pk_mul_f32 v[6:7], v[6:7], v[26:27]
  v_pk_mul_f32 v[8:9], v[8:9], v[28:29]
  v_pk_mul_f32 v[10:11], v[10:11], v[30:31]
  v_pk_mul_f32 v[12:13], v[12:13], v[32:33]
  v_pk_mul_f32 v[14:15], v[14:15], v[34:35]
  v_pk_mul_f32 v[16:17], v[16:17], v[36:37]
  v_pk_mul_f32 v[18:19], v[18:19], v[38:39]
  v_cvt_pk_bf16_f32 v40, v0, v1
  v_cvt_pk_bf16_f32 v41, v2, v3
  ds_write_b64 v165, v[40:41] offset:11360
  v_cvt_pk_bf16_f32 v42, v4, v5
  v_cvt_pk_bf16_f32 v43, v6, v7
  ds_write_b64 v165, v[42:43] offset:11392
  v_cvt_pk_bf16_f32 v44, v8, v9
  v_cvt_pk_bf16_f32 v45, v10, v11
  ds_write_b64 v165, v[44:45] offset:33888
  v_cvt_pk_bf16_f32 v46, v12, v13
  v_cvt_pk_bf16_f32 v47, v14, v15
  ds_write_b64 v165, v[46:47] offset:33920
  v_cvt_pk_bf16_f32 v48, v16, v17
  v_cvt_pk_bf16_f32 v49, v18, v19
  ds_write_b64 v165, v[48:49] offset:33856
  v_pk_fma_f32 v[0:1], v[188:189], v[52:53], v[136:137]
  v_pk_fma_f32 v[2:3], v[190:191], v[54:55], v[138:139]
  v_pk_fma_f32 v[4:5], v[220:221], v[56:57], v[140:141]
  v_pk_fma_f32 v[6:7], v[222:223], v[58:59], v[142:143]
  v_pk_fma_f32 v[8:9], v[204:205], v[52:53], v[136:137]
  v_pk_fma_f32 v[10:11], v[206:207], v[54:55], v[138:139]
  v_pk_fma_f32 v[12:13], v[236:237], v[56:57], v[140:141]
  v_pk_fma_f32 v[14:15], v[238:239], v[58:59], v[142:143]
  v_pk_fma_f32 v[16:17], v[252:253], v[60:61], v[144:145]
  v_pk_fma_f32 v[18:19], v[254:255], v[62:63], v[146:147]
  v_exp_f32 v20, v0
  v_exp_f32 v21, v1
  v_exp_f32 v22, v2
  v_exp_f32 v23, v3
  v_exp_f32 v24, v4
  v_exp_f32 v25, v5
  v_exp_f32 v26, v6
  v_exp_f32 v27, v7
  v_exp_f32 v28, v8
  v_exp_f32 v29, v9
  v_exp_f32 v30, v10
  v_exp_f32 v31, v11
  v_exp_f32 v32, v12
  v_exp_f32 v33, v13
  v_exp_f32 v34, v14
  v_exp_f32 v35, v15
  v_exp_f32 v36, v16
  v_exp_f32 v37, v17
  v_exp_f32 v38, v18
  v_exp_f32 v39, v19
  s_waitcnt lgkmcnt(0)
  s_barrier
  v_pk_fma_f32 v[20:21], v[20:21], v[64:65], v[64:65]
  v_pk_fma_f32 v[22:23], v[22:23], v[64:65], v[64:65]
  v_pk_fma_f32 v[24:25], v[24:25], v[64:65], v[64:65]
  v_pk_fma_f32 v[26:27], v[26:27], v[64:65], v[64:65]
  v_pk_fma_f32 v[28:29], v[28:29], v[64:65], v[64:65]
  v_pk_fma_f32 v[30:31], v[30:31], v[64:65], v[64:65]
  v_pk_fma_f32 v[32:33], v[32:33], v[64:65], v[64:65]
  v_pk_fma_f32 v[34:35], v[34:35], v[64:65], v[64:65]
  v_pk_fma_f32 v[36:37], v[36:37], v[64:65], v[64:65]
  v_pk_fma_f32 v[38:39], v[38:39], v[64:65], v[64:65]
  v_rcp_f32 v20, v20
  v_rcp_f32 v21, v21
  v_rcp_f32 v22, v22
  v_rcp_f32 v23, v23
  v_rcp_f32 v24, v24
  v_rcp_f32 v25, v25
  v_rcp_f32 v26, v26
  v_rcp_f32 v27, v27
  v_rcp_f32 v28, v28
  v_rcp_f32 v29, v29
  v_rcp_f32 v30, v30
  v_rcp_f32 v31, v31
  v_rcp_f32 v32, v32
  v_rcp_f32 v33, v33
  v_rcp_f32 v34, v34
  v_rcp_f32 v35, v35
  v_rcp_f32 v36, v36
  v_rcp_f32 v37, v37
  v_rcp_f32 v38, v38
  v_rcp_f32 v39, v39
  v_pk_mul_f32 v[0:1], v[0:1], v[20:21]
  v_pk_mul_f32 v[2:3], v[2:3], v[22:23]
  v_pk_mul_f32 v[4:5], v[4:5], v[24:25]
  v_pk_mul_f32 v[6:7], v[6:7], v[26:27]
  v_pk_mul_f32 v[8:9], v[8:9], v[28:29]
  v_pk_mul_f32 v[10:11], v[10:11], v[30:31]
  v_pk_mul_f32 v[12:13], v[12:13], v[32:33]
  v_pk_mul_f32 v[14:15], v[14:15], v[34:35]
  v_pk_mul_f32 v[16:17], v[16:17], v[36:37]
  v_pk_mul_f32 v[18:19], v[18:19], v[38:39]
  v_cvt_pk_bf16_f32 v40, v0, v1
  v_cvt_pk_bf16_f32 v41, v2, v3
  ds_write_b64 v165, v[40:41] offset:16992
  v_cvt_pk_bf16_f32 v42, v4, v5
  v_cvt_pk_bf16_f32 v43, v6, v7
  ds_write_b64 v165, v[42:43] offset:17024
  v_cvt_pk_bf16_f32 v44, v8, v9
  v_cvt_pk_bf16_f32 v45, v10, v11
  ds_write_b64 v165, v[44:45] offset:39520
  v_cvt_pk_bf16_f32 v46, v12, v13
  v_cvt_pk_bf16_f32 v47, v14, v15
  ds_write_b64 v165, v[46:47] offset:39552
  v_cvt_pk_bf16_f32 v48, v16, v17
  v_cvt_pk_bf16_f32 v49, v18, v19
  ds_write_b64 v165, v[48:49] offset:39488
  s_waitcnt lgkmcnt(0)
  s_barrier
L_end_hi:
  s_endpgm
.section .rodata,"a"
.p2align 6
.amdhsa_kernel standalone__batchnorm__sampling_kernel
  .amdhsa_next_free_vgpr 256
  .amdhsa_next_free_sgpr 96
  .amdhsa_accum_offset 256
  .amdhsa_group_segment_fixed_size 0
  .amdhsa_kernarg_size 72
  .amdhsa_user_sgpr_count 2
  .amdhsa_user_sgpr_kernarg_segment_ptr 1
  .amdhsa_system_sgpr_workgroup_id_x 1
.end_amdhsa_kernel
```
